```python
import torch

def _softmax(x, axis=-1):
    return torch.softmax(x, dim=axis)
def _gelu(x):
    return torch.nn.functional.gelu(x, approximate="tanh")
def _silu(x):
    return torch.nn.functional.silu(x)
def _sigmoid(x):
    return torch.sigmoid(x)
def _layernorm(x, axis=-1, eps=1e-5):
    m = x.mean(dim=axis, keepdim=True)
    v = x.var(dim=axis, keepdim=True, unbiased=False)
    return (x - m) / torch.sqrt(v + eps)
def _scatter_add(tgt, idx, src, axis=0):
    return tgt.clone().index_add_(axis, idx, src)
def _segment_sum(src, seg, n):
    out = torch.zeros((n,) + src.shape[1:], dtype=src.dtype)
    return out.index_add_(0, seg, src)
def _pad(x, pw):
    flat = tuple(v for pair in reversed(pw) for v in pair)
    return torch.nn.functional.pad(x, flat)

kernel_name = 'sequential_preLN__ssm_conv_s4__moe_arch_mod__prompt'

def setup_inputs():

    _w = (lambda a: (lambda t: t.to(torch.bfloat16) if t.is_floating_point() else t)(torch.as_tensor(a)))
    def _A_setup():
        B, L, D, N = 1, 2048, 640, 192
        A_re = -(lambda _x: torch.exp(torch.as_tensor(_x)))((lambda *s: torch.randn(*s, dtype=torch.bfloat16) * 6.4)(D, N))
        A_im = torch.pi * (lambda *s: torch.randn(*s, dtype=torch.bfloat16) * 0.05)(D, N)
        B_re = (lambda *s: torch.randn(*s, dtype=torch.bfloat16) * 0.05)(D, N)
        B_im = (lambda *s: torch.randn(*s, dtype=torch.bfloat16) * 0.05)(D, N)
        C_re = (lambda *s: torch.randn(*s, dtype=torch.bfloat16) * 0.05)(D, N)
        C_im = (lambda *s: torch.randn(*s, dtype=torch.bfloat16) * 0.05)(D, N)
        log_dt = (lambda *s: torch.randn(*s, dtype=torch.bfloat16) * 0.05)(D) * 0.5 - 4.0
        Dskip = (lambda *s: torch.randn(*s, dtype=torch.bfloat16) * 0.05)(D)
        return {
            "u": _w((lambda *s: torch.randn(*s, dtype=torch.bfloat16) * 0.05)(B, L, D)),
            "A_re": _w(A_re),
            "A_im": _w(A_im),
            "B_re": _w(B_re),
            "B_im": _w(B_im),
            "C_re": _w(C_re),
            "C_im": _w(C_im),
            "log_dt": _w(log_dt),
            "Dskip": _w(Dskip),
        }
    _A_in = _A_setup()

    def _B_setup():
        B, S, D, F, C = 1, 2048, 640, 1536, 1
        return {
            "x": _w((lambda *s: torch.randn(*s, dtype=torch.bfloat16) * 0.05)(B, S, D)),
            "w_r": _w((lambda *s: torch.randn(*s, dtype=torch.bfloat16) * 0.05)(D)),
            "w_gate": _w((lambda *s: torch.randn(*s, dtype=torch.bfloat16) * 0.05)(D, F)),
            "w_up": _w((lambda *s: torch.randn(*s, dtype=torch.bfloat16) * 0.05)(D, F)),
            "w_down": _w((lambda *s: torch.randn(*s, dtype=torch.bfloat16) * 0.05)(F, D)),
        }
    _B_in = _B_setup()

    return {
        "A_u": _A_in["u"],
        "A_A_re": _A_in["A_re"],
        "A_A_im": _A_in["A_im"],
        "A_B_re": _A_in["B_re"],
        "A_B_im": _A_in["B_im"],
        "A_C_re": _A_in["C_re"],
        "A_C_im": _A_in["C_im"],
        "A_log_dt": _A_in["log_dt"],
        "A_Dskip": _A_in["Dskip"],
        "B_x": _B_in["x"],
        "B_w_r": _B_in["w_r"],
        "B_w_gate": _B_in["w_gate"],
        "B_w_up": _B_in["w_up"],
        "B_w_down": _B_in["w_down"],
    }

def reference(A_u, A_A_re, A_A_im, A_B_re, A_B_im, A_C_re, A_C_im, A_log_dt, A_Dskip, B_x, B_w_r, B_w_gate, B_w_up, B_w_down):
    def _A_ref(u, A_re, A_im, B_re, B_im, C_re, C_im, log_dt, Dskip):
        Bsz, L, D = u.shape
        dt = torch.exp(log_dt)[:, None]
        A = A_re + 1j * A_im
        Bc = B_re + 1j * B_im
        Cc = C_re + 1j * C_im
        logdA = dt * A
        dB = dt * Bc
        l = (lambda x, dt: x.to(dt))(torch.arange(L), A_re.dtype)
        P = torch.exp(logdA[:, :, None] * l[None, None, :])
        K = torch.einsum("dn,dnl,dn->dl", Cc, P, dB).real
        L2 = 2 * L
        Kp = _pad(K, ((0, 0), (0, L)))
        up = (lambda x, *d: x.permute(*d))(u, 0, 2, 1)
        up = _pad(up, ((0, 0), (0, 0), (0, L)))
        Kf = (lambda x, axes=(-2,-1): torch.fft.rfft2(x.float(), dim=axes))(Kp[:, None, :], axes=(-2, -1))
        Uf = (lambda x, axes=(-2,-1): torch.fft.rfft2(x.float(), dim=axes))(up[:, :, None, :], axes=(-2, -1))
        Yf = Uf * Kf[None, :, :, :]
        y = (lambda x, s, axes=(-2,-1): torch.fft.irfft2(x, s=s, dim=axes).to(torch.bfloat16))(Yf, (1, L2), axes=(-2, -1))[:, :, 0, :L]
        y = (lambda x, *d: x.permute(*d))(y, 0, 2, 1) + u * Dskip[None, None, :]
        return y

    def _B_ref(x, w_r, w_gate, w_up, w_down):
        B, S, D = x.shape
        C = 1
        r = x @ w_r
        idx = torch.argsort(-r, axis=-1)[:, :C]
        idx_e = (lambda x, n, axis: torch.repeat_interleave(x, n, dim=axis))(idx.reshape(B, C, 1), D, axis=2)
        x_sel = (lambda x, i, axis: torch.take_along_dim(x, i, dim=axis))(x, idx_e, axis=1)
        g = _silu(x_sel @ w_gate)
        u = x_sel @ w_up
        y = (g * u) @ w_down
        r_sel = _sigmoid((lambda x, i, axis: torch.take_along_dim(x, i, dim=axis))(r, idx, axis=1))
        y = y * r_sel.reshape(B, C, 1)
        b_off = (torch.arange(B) * S).reshape(B, 1)
        flat_idx = (idx + b_off).reshape(B * C)
        zero = (x * 0.0).reshape(B * S, D)
        upd = _scatter_add(zero, flat_idx, y.reshape(B * C, D), axis=0)
        return x + upd.reshape(B, S, D)

    x = A_u
    h = x + _A_ref(_layernorm(x, axis=-1), A_A_re, A_A_im, A_B_re, A_B_im, A_C_re, A_C_im, A_log_dt, A_Dskip)
    h2 = h + _B_ref(_layernorm(h, axis=-1), B_w_r, B_w_gate, B_w_up, B_w_down)
    return h2
```

```asm
; @launch kernel=ln1_kernel grid=(256,1,1) block=(256,1,1) lds=10240
; @launch kernel=main1_kernel grid=(640,1,1) block=(256,1,1) lds=52288
; @launch kernel=tail_kernel grid=(256,1,1) block=(256,1,1) lds=5376
.amdgcn_target "amdgcn-amd-amdhsa--gfx950"
.text
.globl ln1_kernel
.p2align 8
.type ln1_kernel,@function
ln1_kernel:
    s_cmp_ge_u32 s2, 256
    s_cbranch_scc1 L_kln1_done
    s_load_dwordx2 s[4:5], s[0:1], 0
    s_load_dwordx2 s[6:7], s[0:1], 128
    v_lshrrev_b32 v1, 6, v0
    v_and_b32 v2, 63, v0
    s_nop 0
    v_readfirstlane_b32 s3, v1
    s_waitcnt lgkmcnt(0)
    s_mov_b32 s8, s4
    s_mov_b32 s9, s5
    s_mov_b32 s10, 2621440
    s_mov_b32 s11, 0x00020000
    s_mov_b32 s12, s6
    s_mov_b32 s13, s7
    s_mov_b32 s14, 268435456
    s_mov_b32 s15, 0x00020000
    s_lshl_b32 s16, s2, 3
    s_lshl_b32 s17, s3, 1
    s_add_u32 s16, s16, s17
    s_mul_i32 s17, s16, 1280
    v_lshlrev_b32 v3, 2, v2
    buffer_load_dword v6, v3, s[8:11], s17 offen offset:0
    buffer_load_dword v7, v3, s[8:11], s17 offen offset:256
    buffer_load_dword v8, v3, s[8:11], s17 offen offset:512
    buffer_load_dword v9, v3, s[8:11], s17 offen offset:768
    buffer_load_dword v10, v3, s[8:11], s17 offen offset:1024
    buffer_load_dword v11, v3, s[8:11], s17 offen offset:1280
    buffer_load_dword v12, v3, s[8:11], s17 offen offset:1536
    buffer_load_dword v13, v3, s[8:11], s17 offen offset:1792
    buffer_load_dword v14, v3, s[8:11], s17 offen offset:2048
    buffer_load_dword v15, v3, s[8:11], s17 offen offset:2304
    s_cmp_ge_u32 s2, 3
    s_cbranch_scc1 L_kln1_noz
    v_mov_b32 v60, 0
    v_mov_b32 v61, 0
    v_mov_b32 v62, 0
    v_mov_b32 v63, 0
    v_lshlrev_b32 v59, 4, v0
    s_lshl_b32 s18, s2, 12
    s_add_u32 s18, s18, 13697024
    s_cmp_eq_u32 s2, 2
    s_cselect_b32 s18, 12582912, s18
    buffer_store_dwordx4 v[60:63], v59, s[12:15], s18 offen
L_kln1_noz:
    s_waitcnt vmcnt(0)
    s_mov_b32 s48, 0x3acccccd
    s_mov_b32 s50, 0x3727c5ac
    v_lshlrev_b32 v32, 16, v6
    v_lshlrev_b32 v33, 16, v11
    v_and_b32 v34, 0xffff0000, v6
    v_and_b32 v35, 0xffff0000, v11
    v_lshlrev_b32 v36, 16, v7
    v_lshlrev_b32 v37, 16, v12
    v_and_b32 v38, 0xffff0000, v7
    v_and_b32 v39, 0xffff0000, v12
    v_lshlrev_b32 v40, 16, v8
    v_lshlrev_b32 v41, 16, v13
    v_and_b32 v42, 0xffff0000, v8
    v_and_b32 v43, 0xffff0000, v13
    v_lshlrev_b32 v44, 16, v9
    v_lshlrev_b32 v45, 16, v14
    v_and_b32 v46, 0xffff0000, v9
    v_and_b32 v47, 0xffff0000, v14
    v_lshlrev_b32 v48, 16, v10
    v_lshlrev_b32 v49, 16, v15
    v_and_b32 v50, 0xffff0000, v10
    v_and_b32 v51, 0xffff0000, v15
    v_pk_add_f32 v[52:53], v[32:33], v[34:35]
    v_pk_add_f32 v[54:55], v[36:37], v[38:39]
    v_pk_add_f32 v[52:53], v[52:53], v[40:41]
    v_pk_add_f32 v[54:55], v[54:55], v[42:43]
    v_pk_add_f32 v[52:53], v[52:53], v[44:45]
    v_pk_add_f32 v[54:55], v[54:55], v[46:47]
    v_pk_add_f32 v[52:53], v[52:53], v[48:49]
    v_pk_add_f32 v[54:55], v[54:55], v[50:51]
    v_pk_add_f32 v[52:53], v[52:53], v[54:55]
    s_nop 1
    v_add_f32_dpp v52, v52, v52 row_shr:1 row_mask:0xf bank_mask:0xf
    v_add_f32_dpp v53, v53, v53 row_shr:1 row_mask:0xf bank_mask:0xf
    s_nop 0
    v_add_f32_dpp v52, v52, v52 row_shr:2 row_mask:0xf bank_mask:0xf
    v_add_f32_dpp v53, v53, v53 row_shr:2 row_mask:0xf bank_mask:0xf
    s_nop 0
    v_add_f32_dpp v52, v52, v52 row_shr:4 row_mask:0xf bank_mask:0xf
    v_add_f32_dpp v53, v53, v53 row_shr:4 row_mask:0xf bank_mask:0xf
    s_nop 0
    v_add_f32_dpp v52, v52, v52 row_shr:8 row_mask:0xf bank_mask:0xf
    v_add_f32_dpp v53, v53, v53 row_shr:8 row_mask:0xf bank_mask:0xf
    s_nop 0
    v_add_f32_dpp v52, v52, v52 row_bcast:15 row_mask:0xa bank_mask:0xf
    v_add_f32_dpp v53, v53, v53 row_bcast:15 row_mask:0xa bank_mask:0xf
    s_nop 0
    v_add_f32_dpp v52, v52, v52 row_bcast:31 row_mask:0xc bank_mask:0xf
    v_add_f32_dpp v53, v53, v53 row_bcast:31 row_mask:0xc bank_mask:0xf
    s_nop 0
    s_nop 0
    v_pk_mul_f32 v[52:53], v[52:53], s[48:49] op_sel_hi:[1,0]
    s_nop 0
    v_readlane_b32 s40, v52, 63
    v_readlane_b32 s41, v53, 63
    v_cvt_pk_bf16_f32 v54, v52, v53
    v_lshlrev_b32 v52, 16, v54
    v_and_b32 v53, 0xffff0000, v54
    s_nop 0
    v_readlane_b32 s42, v52, 63
    v_readlane_b32 s43, v53, 63
    v_pk_add_f32 v[54:55], v[32:33], s[40:41] neg_lo:[0,1] neg_hi:[0,1]
    v_pk_mul_f32 v[52:53], v[54:55], v[54:55]
    v_pk_add_f32 v[54:55], v[34:35], s[40:41] neg_lo:[0,1] neg_hi:[0,1]
    v_pk_fma_f32 v[52:53], v[54:55], v[54:55], v[52:53]
    v_pk_add_f32 v[54:55], v[36:37], s[40:41] neg_lo:[0,1] neg_hi:[0,1]
    v_pk_fma_f32 v[52:53], v[54:55], v[54:55], v[52:53]
    v_pk_add_f32 v[54:55], v[38:39], s[40:41] neg_lo:[0,1] neg_hi:[0,1]
    v_pk_fma_f32 v[52:53], v[54:55], v[54:55], v[52:53]
    v_pk_add_f32 v[54:55], v[40:41], s[40:41] neg_lo:[0,1] neg_hi:[0,1]
    v_pk_fma_f32 v[52:53], v[54:55], v[54:55], v[52:53]
    v_pk_add_f32 v[54:55], v[42:43], s[40:41] neg_lo:[0,1] neg_hi:[0,1]
    v_pk_fma_f32 v[52:53], v[54:55], v[54:55], v[52:53]
    v_pk_add_f32 v[54:55], v[44:45], s[40:41] neg_lo:[0,1] neg_hi:[0,1]
    v_pk_fma_f32 v[52:53], v[54:55], v[54:55], v[52:53]
    v_pk_add_f32 v[54:55], v[46:47], s[40:41] neg_lo:[0,1] neg_hi:[0,1]
    v_pk_fma_f32 v[52:53], v[54:55], v[54:55], v[52:53]
    v_pk_add_f32 v[54:55], v[48:49], s[40:41] neg_lo:[0,1] neg_hi:[0,1]
    v_pk_fma_f32 v[52:53], v[54:55], v[54:55], v[52:53]
    v_pk_add_f32 v[54:55], v[50:51], s[40:41] neg_lo:[0,1] neg_hi:[0,1]
    v_pk_fma_f32 v[52:53], v[54:55], v[54:55], v[52:53]
    s_nop 1
    v_add_f32_dpp v52, v52, v52 row_shr:1 row_mask:0xf bank_mask:0xf
    v_add_f32_dpp v53, v53, v53 row_shr:1 row_mask:0xf bank_mask:0xf
    s_nop 0
    v_add_f32_dpp v52, v52, v52 row_shr:2 row_mask:0xf bank_mask:0xf
    v_add_f32_dpp v53, v53, v53 row_shr:2 row_mask:0xf bank_mask:0xf
    s_nop 0
    v_add_f32_dpp v52, v52, v52 row_shr:4 row_mask:0xf bank_mask:0xf
    v_add_f32_dpp v53, v53, v53 row_shr:4 row_mask:0xf bank_mask:0xf
    s_nop 0
    v_add_f32_dpp v52, v52, v52 row_shr:8 row_mask:0xf bank_mask:0xf
    v_add_f32_dpp v53, v53, v53 row_shr:8 row_mask:0xf bank_mask:0xf
    s_nop 0
    v_add_f32_dpp v52, v52, v52 row_bcast:15 row_mask:0xa bank_mask:0xf
    v_add_f32_dpp v53, v53, v53 row_bcast:15 row_mask:0xa bank_mask:0xf
    s_nop 0
    v_add_f32_dpp v52, v52, v52 row_bcast:31 row_mask:0xc bank_mask:0xf
    v_add_f32_dpp v53, v53, v53 row_bcast:31 row_mask:0xc bank_mask:0xf
    s_nop 0
    s_nop 0
    v_pk_mul_f32 v[52:53], v[52:53], s[48:49] op_sel_hi:[1,0]
    v_cvt_pk_bf16_f32 v54, v52, v53
    v_lshlrev_b32 v52, 16, v54
    v_and_b32 v53, 0xffff0000, v54
    v_pk_add_f32 v[52:53], v[52:53], s[50:51] op_sel_hi:[1,0]
    v_cvt_pk_bf16_f32 v54, v52, v53
    v_lshlrev_b32 v52, 16, v54
    v_and_b32 v53, 0xffff0000, v54
    v_sqrt_f32 v52, v52
    v_sqrt_f32 v53, v53
    s_nop 0
    v_cvt_pk_bf16_f32 v54, v52, v53
    v_lshlrev_b32 v52, 16, v54
    v_and_b32 v53, 0xffff0000, v54
    v_rcp_f32 v52, v52
    v_rcp_f32 v53, v53
    s_nop 0
    v_readlane_b32 s44, v52, 63
    v_readlane_b32 s45, v53, 63
    s_nop 1
    v_lshlrev_b32 v56, 5, v2
    s_lshl_b32 s46, s3, 2
    v_add_u32 v56, s46, v56
    v_pk_add_f32 v[32:33], v[32:33], s[42:43] neg_lo:[0,1] neg_hi:[0,1]
    v_cvt_pk_bf16_f32 v54, v32, v33
    v_lshlrev_b32 v32, 16, v54
    v_and_b32 v33, 0xffff0000, v54
    v_pk_mul_f32 v[32:33], v[32:33], s[44:45]
    v_cvt_pk_bf16_f32 v54, v32, v33
    v_lshlrev_b32 v32, 16, v54
    v_and_b32 v33, 0xffff0000, v54
    v_cvt_pk_f16_f32 v32, v32, v33
    ds_write_b32 v56, v32 offset:0
    v_pk_add_f32 v[34:35], v[34:35], s[42:43] neg_lo:[0,1] neg_hi:[0,1]
    v_cvt_pk_bf16_f32 v54, v34, v35
    v_lshlrev_b32 v34, 16, v54
    v_and_b32 v35, 0xffff0000, v54
    v_pk_mul_f32 v[34:35], v[34:35], s[44:45]
    v_cvt_pk_bf16_f32 v54, v34, v35
    v_lshlrev_b32 v34, 16, v54
    v_and_b32 v35, 0xffff0000, v54
    v_cvt_pk_f16_f32 v34, v34, v35
    ds_write_b32 v56, v34 offset:16
    v_pk_add_f32 v[36:37], v[36:37], s[42:43] neg_lo:[0,1] neg_hi:[0,1]
    v_cvt_pk_bf16_f32 v54, v36, v37
    v_lshlrev_b32 v36, 16, v54
    v_and_b32 v37, 0xffff0000, v54
    v_pk_mul_f32 v[36:37], v[36:37], s[44:45]
    v_cvt_pk_bf16_f32 v54, v36, v37
    v_lshlrev_b32 v36, 16, v54
    v_and_b32 v37, 0xffff0000, v54
    v_cvt_pk_f16_f32 v36, v36, v37
    ds_write_b32 v56, v36 offset:2048
    v_pk_add_f32 v[38:39], v[38:39], s[42:43] neg_lo:[0,1] neg_hi:[0,1]
    v_cvt_pk_bf16_f32 v54, v38, v39
    v_lshlrev_b32 v38, 16, v54
    v_and_b32 v39, 0xffff0000, v54
    v_pk_mul_f32 v[38:39], v[38:39], s[44:45]
    v_cvt_pk_bf16_f32 v54, v38, v39
    v_lshlrev_b32 v38, 16, v54
    v_and_b32 v39, 0xffff0000, v54
    v_cvt_pk_f16_f32 v38, v38, v39
    ds_write_b32 v56, v38 offset:2064
    v_pk_add_f32 v[40:41], v[40:41], s[42:43] neg_lo:[0,1] neg_hi:[0,1]
    v_cvt_pk_bf16_f32 v54, v40, v41
    v_lshlrev_b32 v40, 16, v54
    v_and_b32 v41, 0xffff0000, v54
    v_pk_mul_f32 v[40:41], v[40:41], s[44:45]
    v_cvt_pk_bf16_f32 v54, v40, v41
    v_lshlrev_b32 v40, 16, v54
    v_and_b32 v41, 0xffff0000, v54
    v_cvt_pk_f16_f32 v40, v40, v41
    ds_write_b32 v56, v40 offset:4096
    v_pk_add_f32 v[42:43], v[42:43], s[42:43] neg_lo:[0,1] neg_hi:[0,1]
    v_cvt_pk_bf16_f32 v54, v42, v43
    v_lshlrev_b32 v42, 16, v54
    v_and_b32 v43, 0xffff0000, v54
    v_pk_mul_f32 v[42:43], v[42:43], s[44:45]
    v_cvt_pk_bf16_f32 v54, v42, v43
    v_lshlrev_b32 v42, 16, v54
    v_and_b32 v43, 0xffff0000, v54
    v_cvt_pk_f16_f32 v42, v42, v43
    ds_write_b32 v56, v42 offset:4112
    v_pk_add_f32 v[44:45], v[44:45], s[42:43] neg_lo:[0,1] neg_hi:[0,1]
    v_cvt_pk_bf16_f32 v54, v44, v45
    v_lshlrev_b32 v44, 16, v54
    v_and_b32 v45, 0xffff0000, v54
    v_pk_mul_f32 v[44:45], v[44:45], s[44:45]
    v_cvt_pk_bf16_f32 v54, v44, v45
    v_lshlrev_b32 v44, 16, v54
    v_and_b32 v45, 0xffff0000, v54
    v_cvt_pk_f16_f32 v44, v44, v45
    ds_write_b32 v56, v44 offset:6144
    v_pk_add_f32 v[46:47], v[46:47], s[42:43] neg_lo:[0,1] neg_hi:[0,1]
    v_cvt_pk_bf16_f32 v54, v46, v47
    v_lshlrev_b32 v46, 16, v54
    v_and_b32 v47, 0xffff0000, v54
    v_pk_mul_f32 v[46:47], v[46:47], s[44:45]
    v_cvt_pk_bf16_f32 v54, v46, v47
    v_lshlrev_b32 v46, 16, v54
    v_and_b32 v47, 0xffff0000, v54
    v_cvt_pk_f16_f32 v46, v46, v47
    ds_write_b32 v56, v46 offset:6160
    v_pk_add_f32 v[48:49], v[48:49], s[42:43] neg_lo:[0,1] neg_hi:[0,1]
    v_cvt_pk_bf16_f32 v54, v48, v49
    v_lshlrev_b32 v48, 16, v54
    v_and_b32 v49, 0xffff0000, v54
    v_pk_mul_f32 v[48:49], v[48:49], s[44:45]
    v_cvt_pk_bf16_f32 v54, v48, v49
    v_lshlrev_b32 v48, 16, v54
    v_and_b32 v49, 0xffff0000, v54
    v_cvt_pk_f16_f32 v48, v48, v49
    ds_write_b32 v56, v48 offset:8192
    v_pk_add_f32 v[50:51], v[50:51], s[42:43] neg_lo:[0,1] neg_hi:[0,1]
    v_cvt_pk_bf16_f32 v54, v50, v51
    v_lshlrev_b32 v50, 16, v54
    v_and_b32 v51, 0xffff0000, v54
    v_pk_mul_f32 v[50:51], v[50:51], s[44:45]
    v_cvt_pk_bf16_f32 v54, v50, v51
    v_lshlrev_b32 v50, 16, v54
    v_and_b32 v51, 0xffff0000, v54
    v_cvt_pk_f16_f32 v50, v50, v51
    ds_write_b32 v56, v50 offset:8208
    v_lshlrev_b32 v57, 4, v0
    s_mul_i32 s46, s2, 10368
    s_add_u32 s46, s46, 0
    s_add_u32 s47, s46, 8192
    s_add_u32 s39, s46, 4096
    s_waitcnt lgkmcnt(0)
    s_barrier
    ds_read_b128 v[32:35], v57
    ds_read_b128 v[36:39], v57 offset:4096
    s_cmp_ge_u32 s3, 2
    s_cbranch_scc1 L_ln1_skip3
    ds_read_b128 v[40:43], v57 offset:8192
    s_waitcnt lgkmcnt(0)
    buffer_store_dwordx4 v[40:43], v57, s[12:15], s47 offen
L_ln1_skip3:
    s_waitcnt lgkmcnt(0)
    buffer_store_dwordx4 v[32:35], v57, s[12:15], s46 offen
    buffer_store_dwordx4 v[36:39], v57, s[12:15], s39 offen
L_kln1_done:
    s_endpgm
.globl main1_kernel
.p2align 8
.type main1_kernel,@function
main1_kernel:
    s_cmp_ge_u32 s2, 640
    s_cbranch_scc1 L_m1_done
    s_and_b32 s16, s2, 7
    s_mul_i32 s16, s16, 80
    s_lshr_b32 s2, s2, 3
    s_add_u32 s2, s2, s16
    s_setprio 3
    s_load_dwordx4 s[48:51], s[0:1], 8
    s_load_dwordx4 s[52:55], s[0:1], 24
    s_load_dwordx4 s[56:59], s[0:1], 40
    s_load_dwordx4 s[60:63], s[0:1], 56
    s_load_dwordx2 s[66:67], s[0:1], 128
    s_load_dwordx4 s[72:75], s[0:1], 88
    s_load_dwordx2 s[76:77], s[0:1], 104
    v_lshrrev_b32 v1, 6, v0
    v_and_b32 v2, 63, v0
    s_nop 0
    v_readfirstlane_b32 s3, v1
    v_min_u32 v3, 47, v2
    s_mul_i32 s20, s2, 384
    s_mul_i32 s21, s3, 96
    s_add_u32 s20, s20, s21
    v_lshlrev_b32 v3, 1, v3
    v_add_u32 v3, s20, v3
    s_lshl_b32 s21, s2, 1
    v_mov_b32 v4, s21
    s_and_b32 s22, s21, 0xfffffffc
    v_subrev_u32 v5, 1, v0
    s_mov_b32 s32, 10368
    v_mul_lo_u32 v5, v5, s32
    s_lshl_b32 s32, s2, 4
    v_add_u32 v5, s32, v5
    v_add_u32 v6, 10368, v5
    s_waitcnt lgkmcnt(0)
    global_load_ushort v20, v3, s[48:49]
    global_load_ushort v21, v3, s[50:51]
    global_load_ushort v22, v3, s[52:53]
    global_load_ushort v23, v3, s[54:55]
    global_load_ushort v24, v3, s[56:57]
    global_load_ushort v25, v3, s[58:59]
    global_load_ushort v26, v4, s[60:61]
    s_mov_b32 s24, s66
    s_mov_b32 s25, s67
    s_add_u32 s24, s24, 0
    s_addc_u32 s25, s25, 0
    s_mov_b32 s26, 2664576
    s_mov_b32 s27, 0x00020000
    s_load_dword s68, s[62:63], s22
    s_mov_b32 s12, s66
    s_mov_b32 s13, s67
    s_mov_b32 s14, 268435456
    s_mov_b32 s15, 0x00020000
    v_and_b32 v12, 15, v2
    v_lshrrev_b32 v13, 4, v2
    v_cvt_f32_u32 v14, v12
    s_mul_i32 s30, s3, 5120
    v_and_b32 v15, 7, v2
    v_mul_u32_u24 v16, 240, v15
    v_add_u32 v17, 240, v16
    v_add_u32 v18, 304, v16
    v_cmp_lt_u32 vcc, 2, v15
    v_mov_b32 v19, 256
    v_lshrrev_b32 v27, 3, v2
    v_cndmask_b32 v17, v17, v18, vcc
    v_cmp_eq_u32 vcc, 0, v15
    v_lshlrev_b32 v27, 4, v27
    v_add_u32 v27, s30, v27
    v_cndmask_b32 v17, v17, v19, vcc
    v_cvt_f32_u32 v15, v17
    v_lshrrev_b32 v28, 3, v2
    v_mul_u32_u24 v28, 80, v28
    v_and_b32 v29, 7, v2
    v_lshl_add_u32 v28, v29, 3, v28
    v_add_u32 v28, s30, v28
    v_lshlrev_b32 v29, 4, v2
    v_add_u32 v29, s30, v29
    v_lshlrev_b32 v30, 6, v13
    v_add_u32 v30, s30, v30
    v_lshrrev_b32 v16, 2, v12
    v_subrev_u32 v16, 1, v16
    v_max_i32 v16, 0, v16
    v_lshrrev_b32 v17, 1, v12
    v_add_u32 v17, 3, v17
    v_min_u32 v17, 7, v17
    v_mul_u32_u24 v18, 320, v13
    v_add_u32 v18, s30, v18
    v_lshl_add_u32 v31, v16, 3, v18
    v_lshl_add_u32 v16, v17, 3, v18
    v_cmp_gt_u32 s[36:37], 8, v12
    s_mul_i32 s31, s3, 3072
    s_add_u32 s31, s31, 38400
    v_lshlrev_b32 v32, 6, v12
    v_lshl_add_u32 v32, v13, 4, v32
    v_add_u32 v144, s31, v32
    v_lshlrev_b32 v33, 5, v12
    v_lshl_add_u32 v33, v13, 4, v33
    v_add_u32 v33, 1024, v33
    v_lshlrev_b32 v34, 4, v12
    v_lshl_add_u32 v34, v13, 8, v34
    v_add_u32 v34, 1024, v34
    v_cmp_gt_u32 vcc, 2, v13
    v_lshlrev_b32 v35, 3, v12
    v_lshl_add_u32 v35, v13, 8, v35
    v_add_u32 v35, 2048, v35
    v_lshlrev_b32 v36, 3, v2
    v_add_u32 v36, 2304, v36
    v_cndmask_b32 v33, v34, v33, vcc
    v_cndmask_b32 v35, v36, v35, vcc
    v_add_u32 v145, s31, v33
    v_add_u32 v146, s31, v35
    v_lshlrev_b32 v37, 3, v0
    v_sub_u32 v37, 2047, v37
    v_cmp_le_u32 vcc, 240, v0
    v_subrev_u32 v40, 0, v37
    v_subrev_u32 v41, 1, v37
    v_subrev_u32 v42, 2, v37
    v_subrev_u32 v43, 3, v37
    v_subrev_u32 v44, 4, v37
    v_subrev_u32 v45, 5, v37
    v_subrev_u32 v46, 6, v37
    v_subrev_u32 v47, 7, v37
    v_cvt_f32_u32 v48, v40
    v_cvt_f32_u32 v49, v41
    v_cvt_f32_u32 v50, v42
    v_cvt_f32_u32 v51, v43
    v_cvt_f32_u32 v52, v44
    v_cvt_f32_u32 v53, v45
    v_cvt_f32_u32 v54, v46
    v_cvt_f32_u32 v55, v47
    v_cvt_pk_bf16_f32 v56, v48, v49
    v_cvt_pk_bf16_f32 v57, v50, v51
    v_cvt_pk_bf16_f32 v58, v52, v53
    v_cvt_pk_bf16_f32 v59, v54, v55
    v_and_b32 v48, 0xffff, v56
    v_lshrrev_b32 v49, 16, v56
    v_and_b32 v50, 0xffff, v57
    v_lshrrev_b32 v51, 16, v57
    v_and_b32 v52, 0xffff, v58
    v_lshrrev_b32 v53, 16, v58
    v_and_b32 v54, 0xffff, v59
    v_lshrrev_b32 v55, 16, v59
    v_subrev_u32 v48, 17024, v48
    v_subrev_u32 v49, 17024, v49
    v_subrev_u32 v50, 17024, v50
    v_subrev_u32 v51, 17024, v51
    v_subrev_u32 v52, 17024, v52
    v_subrev_u32 v53, 17024, v53
    v_subrev_u32 v54, 17024, v54
    v_subrev_u32 v55, 17024, v55
    v_cndmask_b32 v48, v48, v40, vcc
    v_cndmask_b32 v49, v49, v41, vcc
    v_cndmask_b32 v50, v50, v42, vcc
    v_cndmask_b32 v51, v51, v43, vcc
    v_cndmask_b32 v52, v52, v44, vcc
    v_cndmask_b32 v53, v53, v45, vcc
    v_cndmask_b32 v54, v54, v46, vcc
    v_cndmask_b32 v55, v55, v47, vcc
    v_lshlrev_b32 v147, 1, v48
    v_lshlrev_b32 v148, 1, v49
    v_lshlrev_b32 v149, 1, v50
    v_lshlrev_b32 v150, 1, v51
    v_lshlrev_b32 v151, 1, v52
    v_lshlrev_b32 v152, 1, v53
    v_lshlrev_b32 v153, 1, v54
    v_lshlrev_b32 v154, 1, v55
    v_lshlrev_b32 v9, 4, v0
    v_min_u32 v10, 8, v2
    v_mul_u32_u24 v10, 4160, v10
    v_cmp_lt_u32 vcc, 7, v2
    v_min_u32 v11, 31, v0
    v_lshlrev_b32 v11, 4, v11
    v_cndmask_b32 v10, v10, 16, vcc
    v_min_u32 v39, 191, v0
    v_lshlrev_b32 v155, 3, v39
    v_lshlrev_b32 v156, 4, v39
    v_add_u32 v40, 1, v12
    v_and_b32 v157, 7, v40
    v_mul_u32_u24 v157, 4160, v157
    v_lshrrev_b32 v40, 3, v40
    v_add_u32 v40, v40, v13
    v_lshl_add_u32 v157, v40, 4, v157
    s_lshl_b32 s22, s3, 7
    v_add_u32 v157, s22, v157
    v_lshlrev_b32 v158, 5, v12
    v_lshlrev_b32 v40, 4, v13
    v_sub_u32 v158, v40, v158
    s_add_u32 s22, s22, 33792
    v_add_u32 v158, s22, v158
    s_lshl_b32 s22, s3, 13
    v_lshrrev_b32 v159, 1, v13
    v_lshl_add_u32 v159, v159, 3, v12
    v_and_b32 v159, 15, v159
    v_lshl_add_u32 v159, v13, 4, v159
    v_lshlrev_b32 v159, 4, v159
    v_add_u32 v159, s22, v159
    v_and_b32 v40, 1, v0
    v_bfe_u32 v160, v0, 1, 4
    v_lshl_add_u32 v160, v40, 3, v160
    v_and_b32 v160, 15, v160
    v_lshl_add_u32 v160, v40, 5, v160
    v_lshlrev_b32 v160, 4, v160
    v_lshrrev_b32 v40, 5, v0
    v_lshl_add_u32 v160, v40, 10, v160
    s_waitcnt vmcnt(0) lgkmcnt(0)
    v_lshlrev_b32 v20, 16, v20
    v_lshlrev_b32 v21, 16, v21
    v_lshlrev_b32 v22, 16, v22
    v_lshlrev_b32 v23, 16, v23
    v_lshlrev_b32 v24, 16, v24
    v_lshlrev_b32 v25, 16, v25
    v_lshlrev_b32 v26, 16, v26
    v_mul_f32 v26, 0x3fb8aa3b, v26
    v_exp_f32 v26, v26
    s_nop 0
    v_cvt_pk_bf16_f32 v26, v26, v26
    v_lshlrev_b32 v26, 16, v26
    v_mul_f32 v32, v26, v20
    v_mul_f32 v33, v26, v21
    v_mul_f32 v32, 0x3fb8aa3b, v32
    v_mul_f32 v33, 0x3e22f983, v33
    v_mul_f32 v22, v26, v22
    v_mul_f32 v23, v26, v23
    v_rndne_f32 v20, v33
    v_mul_f32 v34, v25, v23
    v_mul_f32 v35, v25, v22
    v_sub_f32 v33, v33, v20
    v_fma_f32 v34, v24, v22, -v34
    v_fma_f32 v35, v24, v23, v35
    ds_write_b64 v29, v[32:33]
    v_max_f32 v20, abs(v34), abs(v35)
    s_waitcnt lgkmcnt(0)
    ds_read_b64 v[36:37], v27 offset:0
    ds_read_b64 v[38:39], v27 offset:128
    ds_read_b64 v[40:41], v27 offset:256
    ds_read_b64 v[42:43], v27 offset:384
    ds_read_b64 v[44:45], v27 offset:512
    ds_read_b64 v[46:47], v27 offset:640
    s_nop 1
    v_max_f32_dpp v20, v20, v20 row_shr:1 row_mask:0xf bank_mask:0xf
    s_nop 1
    v_max_f32_dpp v20, v20, v20 row_shr:2 row_mask:0xf bank_mask:0xf
    s_nop 1
    v_max_f32_dpp v20, v20, v20 row_shr:4 row_mask:0xf bank_mask:0xf
    s_nop 1
    v_max_f32_dpp v20, v20, v20 row_shr:8 row_mask:0xf bank_mask:0xf
    s_nop 1
    v_max_f32_dpp v20, v20, v20 row_bcast:15 row_mask:0xa bank_mask:0xf
    s_nop 1
    v_max_f32_dpp v20, v20, v20 row_bcast:31 row_mask:0xc bank_mask:0xf
    s_nop 1
    s_nop 0
    v_frexp_exp_i32_f32 v20, v20
    s_nop 0
    v_readlane_b32 s23, v20, 63
    s_nop 3
    s_sub_u32 s28, 127, s23
    s_lshl_b32 s28, s28, 23
    s_add_u32 s29, 127, s23
    s_lshl_b32 s29, s29, 23
    v_mul_f32 v34, s28, v34
    v_mul_f32 v35, s28, v35
    v_mov_b32 v20, s23
    s_lshl_b32 s31, s3, 2
    s_add_u32 s31, s31, 50688
    v_mov_b32 v21, s31
    s_waitcnt lgkmcnt(0)
    ds_write_b64 v29, v[34:35] offset:8
    ds_write_b32 v21, v20
    v_mul_f32 v36, v36, v15
    v_mul_f32 v37, v37, v15
    v_mul_f32 v38, v38, v15
    v_mul_f32 v39, v39, v15
    v_mul_f32 v40, v40, v15
    v_mul_f32 v41, v41, v15
    v_mul_f32 v42, v42, v15
    v_mul_f32 v43, v43, v15
    v_mul_f32 v44, v44, v15
    v_mul_f32 v45, v45, v15
    v_mul_f32 v46, v46, v15
    v_mul_f32 v47, v47, v15
    v_exp_f32 v36, v36
    v_fract_f32 v37, v37
    v_exp_f32 v38, v38
    v_fract_f32 v39, v39
    v_exp_f32 v40, v40
    v_fract_f32 v41, v41
    v_exp_f32 v42, v42
    v_fract_f32 v43, v43
    v_exp_f32 v44, v44
    v_fract_f32 v45, v45
    v_exp_f32 v46, v46
    v_fract_f32 v47, v47
    v_cos_f32 v48, v37
    v_sin_f32 v49, v37
    v_cos_f32 v50, v39
    v_sin_f32 v51, v39
    v_cos_f32 v52, v41
    v_sin_f32 v53, v41
    v_cos_f32 v54, v43
    v_sin_f32 v55, v43
    v_cos_f32 v56, v45
    v_sin_f32 v57, v45
    v_cos_f32 v58, v47
    v_sin_f32 v59, v47
    v_mul_f32 v48, v36, v48
    v_mul_f32 v49, v36, v49
    ds_write_b64 v28, v[48:49] offset:1024
    v_mul_f32 v50, v38, v50
    v_mul_f32 v51, v38, v51
    ds_write_b64 v28, v[50:51] offset:1664
    v_mul_f32 v52, v40, v52
    v_mul_f32 v53, v40, v53
    ds_write_b64 v28, v[52:53] offset:2304
    v_mul_f32 v54, v42, v54
    v_mul_f32 v55, v42, v55
    ds_write_b64 v28, v[54:55] offset:2944
    v_mul_f32 v56, v44, v56
    v_mul_f32 v57, v44, v57
    ds_write_b64 v28, v[56:57] offset:3584
    v_mul_f32 v58, v46, v58
    v_mul_f32 v59, v46, v59
    ds_write_b64 v28, v[58:59] offset:4224
    v_mov_b32 v80, 0
    v_mov_b32 v81, 0
    v_mov_b32 v82, 0
    v_mov_b32 v83, 0
    v_mov_b32 v84, 0
    v_mov_b32 v85, 0
    v_mov_b32 v86, 0
    v_mov_b32 v87, 0
    v_mov_b32 v88, 0
    v_mov_b32 v89, 0
    v_mov_b32 v90, 0
    v_mov_b32 v91, 0
    s_waitcnt lgkmcnt(0)
    buffer_load_dwordx4 v[132:135], v5, s[24:27], 0 offen
    buffer_load_dwordx4 v[136:139], v6, s[24:27], 0 offen
    s_mov_b32 s34, 0
    s_setprio 2
L_m1_kq:
    ds_read_b128 v[32:35], v30 offset:0
    ds_read_b128 v[40:43], v30 offset:16
    ds_read_b128 v[48:51], v30 offset:32
    ds_read_b128 v[56:59], v30 offset:48
    ds_read_b64 v[36:37], v31 offset:1024
    ds_read_b64 v[38:39], v16 offset:1024
    ds_read_b64 v[44:45], v31 offset:1104
    ds_read_b64 v[46:47], v16 offset:1104
    ds_read_b64 v[52:53], v31 offset:1184
    ds_read_b64 v[54:55], v16 offset:1184
    ds_read_b64 v[60:61], v31 offset:1264
    ds_read_b64 v[62:63], v16 offset:1264
    v_add_u32 v30, 256, v30
    v_add_u32 v31, 1280, v31
    v_add_u32 v16, 1280, v16
    s_waitcnt lgkmcnt(11)
    v_pk_mul_f32 v[92:93], v[32:33], v[14:15] op_sel_hi:[1,0]
    s_waitcnt lgkmcnt(10)
    v_pk_mul_f32 v[102:103], v[40:41], v[14:15] op_sel_hi:[1,0]
    s_waitcnt lgkmcnt(9)
    v_pk_mul_f32 v[112:113], v[48:49], v[14:15] op_sel_hi:[1,0]
    s_waitcnt lgkmcnt(8)
    v_pk_mul_f32 v[122:123], v[56:57], v[14:15] op_sel_hi:[1,0]
    v_exp_f32 v92, v92
    v_cos_f32 v32, v93
    v_sin_f32 v33, v93
    v_exp_f32 v102, v102
    v_cos_f32 v40, v103
    v_sin_f32 v41, v103
    v_exp_f32 v112, v112
    v_cos_f32 v48, v113
    v_sin_f32 v49, v113
    v_exp_f32 v122, v122
    v_cos_f32 v56, v123
    v_sin_f32 v57, v123
    v_pk_mul_f32 v[92:93], v[32:33], v[92:93] op_sel_hi:[1,0]
    v_pk_mul_f32 v[102:103], v[40:41], v[102:103] op_sel_hi:[1,0]
    v_pk_mul_f32 v[112:113], v[48:49], v[112:113] op_sel_hi:[1,0]
    v_pk_mul_f32 v[122:123], v[56:57], v[122:123] op_sel_hi:[1,0]
    v_cvt_pk_f16_f32 v64, v92, -v93
    v_cvt_pk_f16_f32 v65, v102, -v103
    v_cvt_pk_f16_f32 v66, v112, -v113
    v_cvt_pk_f16_f32 v67, v122, -v123
    v_pk_mul_f32 v[100:101], v[92:93], v[92:93] op_sel:[1,1] op_sel_hi:[1,0] neg_lo:[0,1]
    v_pk_mul_f32 v[110:111], v[102:103], v[102:103] op_sel:[1,1] op_sel_hi:[1,0] neg_lo:[0,1]
    v_pk_mul_f32 v[120:121], v[112:113], v[112:113] op_sel:[1,1] op_sel_hi:[1,0] neg_lo:[0,1]
    v_pk_mul_f32 v[130:131], v[122:123], v[122:123] op_sel:[1,1] op_sel_hi:[1,0] neg_lo:[0,1]
    v_pk_fma_f32 v[94:95], v[92:93], v[92:93], v[100:101] op_sel:[0,0,0] op_sel_hi:[0,1,1]
    v_pk_fma_f32 v[104:105], v[102:103], v[102:103], v[110:111] op_sel:[0,0,0] op_sel_hi:[0,1,1]
    v_pk_fma_f32 v[114:115], v[112:113], v[112:113], v[120:121] op_sel:[0,0,0] op_sel_hi:[0,1,1]
    v_pk_fma_f32 v[124:125], v[122:123], v[122:123], v[130:131] op_sel:[0,0,0] op_sel_hi:[0,1,1]
    v_pk_mul_f32 v[100:101], v[94:95], v[94:95] op_sel:[1,1] op_sel_hi:[1,0] neg_lo:[0,1]
    v_pk_mul_f32 v[110:111], v[104:105], v[104:105] op_sel:[1,1] op_sel_hi:[1,0] neg_lo:[0,1]
    v_pk_mul_f32 v[120:121], v[114:115], v[114:115] op_sel:[1,1] op_sel_hi:[1,0] neg_lo:[0,1]
    v_pk_mul_f32 v[130:131], v[124:125], v[124:125] op_sel:[1,1] op_sel_hi:[1,0] neg_lo:[0,1]
    v_pk_fma_f32 v[96:97], v[94:95], v[94:95], v[100:101] op_sel:[0,0,0] op_sel_hi:[0,1,1]
    v_pk_fma_f32 v[106:107], v[104:105], v[104:105], v[110:111] op_sel:[0,0,0] op_sel_hi:[0,1,1]
    v_pk_fma_f32 v[116:117], v[114:115], v[114:115], v[120:121] op_sel:[0,0,0] op_sel_hi:[0,1,1]
    v_pk_fma_f32 v[126:127], v[124:125], v[124:125], v[130:131] op_sel:[0,0,0] op_sel_hi:[0,1,1]
    v_pk_mul_f32 v[100:101], v[96:97], v[96:97] op_sel:[1,1] op_sel_hi:[1,0] neg_lo:[0,1]
    v_pk_mul_f32 v[110:111], v[106:107], v[106:107] op_sel:[1,1] op_sel_hi:[1,0] neg_lo:[0,1]
    v_pk_mul_f32 v[120:121], v[116:117], v[116:117] op_sel:[1,1] op_sel_hi:[1,0] neg_lo:[0,1]
    v_pk_mul_f32 v[130:131], v[126:127], v[126:127] op_sel:[1,1] op_sel_hi:[1,0] neg_lo:[0,1]
    v_pk_fma_f32 v[98:99], v[96:97], v[96:97], v[100:101] op_sel:[0,0,0] op_sel_hi:[0,1,1]
    v_pk_fma_f32 v[108:109], v[106:107], v[106:107], v[110:111] op_sel:[0,0,0] op_sel_hi:[0,1,1]
    v_pk_fma_f32 v[118:119], v[116:117], v[116:117], v[120:121] op_sel:[0,0,0] op_sel_hi:[0,1,1]
    v_pk_fma_f32 v[128:129], v[126:127], v[126:127], v[130:131] op_sel:[0,0,0] op_sel_hi:[0,1,1]
    v_cndmask_b32 v94, v96, v94, s[36:37]
    v_cndmask_b32 v95, v97, v95, s[36:37]
    v_cndmask_b32 v104, v106, v104, s[36:37]
    v_cndmask_b32 v105, v107, v105, s[36:37]
    v_cndmask_b32 v114, v116, v114, s[36:37]
    v_cndmask_b32 v115, v117, v115, s[36:37]
    v_cndmask_b32 v124, v126, v124, s[36:37]
    v_cndmask_b32 v125, v127, v125, s[36:37]
    v_pk_mul_f32 v[100:101], v[98:99], v[98:99] op_sel:[1,1] op_sel_hi:[1,0] neg_lo:[0,1]
    v_pk_mul_f32 v[110:111], v[108:109], v[108:109] op_sel:[1,1] op_sel_hi:[1,0] neg_lo:[0,1]
    v_pk_mul_f32 v[120:121], v[118:119], v[118:119] op_sel:[1,1] op_sel_hi:[1,0] neg_lo:[0,1]
    v_pk_mul_f32 v[130:131], v[128:129], v[128:129] op_sel:[1,1] op_sel_hi:[1,0] neg_lo:[0,1]
    v_pk_fma_f32 v[92:93], v[98:99], v[98:99], v[100:101] op_sel:[0,0,0] op_sel_hi:[0,1,1]
    v_pk_fma_f32 v[102:103], v[108:109], v[108:109], v[110:111] op_sel:[0,0,0] op_sel_hi:[0,1,1]
    v_pk_fma_f32 v[112:113], v[118:119], v[118:119], v[120:121] op_sel:[0,0,0] op_sel_hi:[0,1,1]
    v_pk_fma_f32 v[122:123], v[128:129], v[128:129], v[130:131] op_sel:[0,0,0] op_sel_hi:[0,1,1]
    s_waitcnt lgkmcnt(0)
    v_pk_mul_f32 v[100:101], v[94:95], v[36:37] op_sel:[1,1] op_sel_hi:[1,0] neg_lo:[0,1]
    v_pk_mul_f32 v[110:111], v[104:105], v[44:45] op_sel:[1,1] op_sel_hi:[1,0] neg_lo:[0,1]
    v_pk_mul_f32 v[120:121], v[114:115], v[52:53] op_sel:[1,1] op_sel_hi:[1,0] neg_lo:[0,1]
    v_pk_mul_f32 v[130:131], v[124:125], v[60:61] op_sel:[1,1] op_sel_hi:[1,0] neg_lo:[0,1]
    v_pk_fma_f32 v[100:101], v[94:95], v[36:37], v[100:101] op_sel:[0,0,0] op_sel_hi:[0,1,1]
    v_pk_fma_f32 v[110:111], v[104:105], v[44:45], v[110:111] op_sel:[0,0,0] op_sel_hi:[0,1,1]
    v_pk_fma_f32 v[120:121], v[114:115], v[52:53], v[120:121] op_sel:[0,0,0] op_sel_hi:[0,1,1]
    v_pk_fma_f32 v[130:131], v[124:125], v[60:61], v[130:131] op_sel:[0,0,0] op_sel_hi:[0,1,1]
    v_cvt_pk_f16_f32 v68, v100, -v101
    v_cvt_pk_f16_f32 v69, v110, -v111
    v_cvt_pk_f16_f32 v70, v120, -v121
    v_cvt_pk_f16_f32 v71, v130, -v131
    v_pk_mul_f32 v[100:101], v[98:99], v[38:39] op_sel:[1,1] op_sel_hi:[1,0] neg_lo:[0,1]
    v_pk_mul_f32 v[110:111], v[108:109], v[46:47] op_sel:[1,1] op_sel_hi:[1,0] neg_lo:[0,1]
    v_pk_mul_f32 v[120:121], v[118:119], v[54:55] op_sel:[1,1] op_sel_hi:[1,0] neg_lo:[0,1]
    v_pk_mul_f32 v[130:131], v[128:129], v[62:63] op_sel:[1,1] op_sel_hi:[1,0] neg_lo:[0,1]
    v_pk_fma_f32 v[100:101], v[98:99], v[38:39], v[100:101] op_sel:[0,0,0] op_sel_hi:[0,1,1]
    v_pk_fma_f32 v[110:111], v[108:109], v[46:47], v[110:111] op_sel:[0,0,0] op_sel_hi:[0,1,1]
    v_pk_fma_f32 v[120:121], v[118:119], v[54:55], v[120:121] op_sel:[0,0,0] op_sel_hi:[0,1,1]
    v_pk_fma_f32 v[130:131], v[128:129], v[62:63], v[130:131] op_sel:[0,0,0] op_sel_hi:[0,1,1]
    v_cvt_pk_f16_f32 v72, v100, -v101
    v_cvt_pk_f16_f32 v73, v110, -v111
    v_cvt_pk_f16_f32 v74, v120, -v121
    v_cvt_pk_f16_f32 v75, v130, -v131
    v_pk_mul_f32 v[100:101], v[92:93], v[34:35] op_sel:[1,1] op_sel_hi:[1,0] neg_lo:[0,1]
    v_pk_mul_f32 v[110:111], v[102:103], v[42:43] op_sel:[1,1] op_sel_hi:[1,0] neg_lo:[0,1]
    v_pk_mul_f32 v[120:121], v[112:113], v[50:51] op_sel:[1,1] op_sel_hi:[1,0] neg_lo:[0,1]
    v_pk_mul_f32 v[130:131], v[122:123], v[58:59] op_sel:[1,1] op_sel_hi:[1,0] neg_lo:[0,1]
    v_pk_fma_f32 v[100:101], v[92:93], v[34:35], v[100:101] op_sel:[0,0,0] op_sel_hi:[0,1,1]
    v_pk_fma_f32 v[110:111], v[102:103], v[42:43], v[110:111] op_sel:[0,0,0] op_sel_hi:[0,1,1]
    v_pk_fma_f32 v[120:121], v[112:113], v[50:51], v[120:121] op_sel:[0,0,0] op_sel_hi:[0,1,1]
    v_pk_fma_f32 v[130:131], v[122:123], v[58:59], v[130:131] op_sel:[0,0,0] op_sel_hi:[0,1,1]
    v_cvt_pk_f16_f32 v76, v100, v101
    v_cvt_pk_f16_f32 v77, v110, v111
    v_cvt_pk_f16_f32 v78, v120, v121
    v_cvt_pk_f16_f32 v79, v130, v131
    s_nop 1
    v_mfma_f32_16x16x32_f16 v[80:83], v[64:67], v[76:79], v[80:83]
    v_mfma_f32_16x16x32_f16 v[84:87], v[68:71], v[76:79], v[84:87]
    v_mfma_f32_16x16x32_f16 v[88:91], v[72:75], v[76:79], v[88:91]
    s_cmp_eq_u32 s34, 0
    s_cbranch_scc1 L_m1_p1
    s_setprio 0
    s_branch L_m1_p2
L_m1_p1:
    s_setprio 1
L_m1_p2:
    s_add_u32 s34, s34, 1
    s_cmp_lt_u32 s34, 3
    s_cbranch_scc1 L_m1_kq
    s_setprio 1
    s_nop 7
    v_mul_f32 v80, s29, v80
    v_mul_f32 v81, s29, v81
    v_mul_f32 v82, s29, v82
    v_mul_f32 v83, s29, v83
    v_mul_f32 v84, s29, v84
    v_mul_f32 v85, s29, v85
    v_mul_f32 v86, s29, v86
    v_mul_f32 v87, s29, v87
    v_mul_f32 v88, s29, v88
    v_mul_f32 v89, s29, v89
    v_mul_f32 v90, s29, v90
    v_mul_f32 v91, s29, v91
    ds_write_b128 v144, v[80:83]
    ds_write_b128 v145, v[84:87]
    ds_write_b64 v146, v[88:89]
    ds_write_b64 v146, v[90:91] offset:128
    s_waitcnt vmcnt(0)
    v_min_u32 v7, 191, v0
    v_lshlrev_b32 v7, 4, v7
    s_mul_i32 s33, s2, 3072
    v_add_u32 v7, s33, v7
    global_load_dwordx4 v[140:143], v7, s[72:73]
    global_load_dwordx4 v[140:143], v7, s[74:75]
    global_load_dwordx4 v[140:143], v7, s[76:77]
    v_mov_b32 v100, v133
    v_mov_b32 v101, v134
    v_mov_b32 v102, v135
    v_mov_b32 v103, v136
    v_mov_b32 v104, v137
    v_mov_b32 v105, v138
    v_alignbit_b32 v108, v133, v132, 16
    v_alignbit_b32 v109, v134, v133, 16
    v_alignbit_b32 v110, v135, v134, 16
    v_alignbit_b32 v111, v136, v135, 16
    v_alignbit_b32 v112, v137, v136, 16
    v_alignbit_b32 v113, v138, v137, 16
    v_alignbit_b32 v116, v134, v133, 16
    v_alignbit_b32 v117, v135, v134, 16
    v_alignbit_b32 v118, v136, v135, 16
    v_alignbit_b32 v119, v137, v136, 16
    v_alignbit_b32 v120, v138, v137, 16
    v_alignbit_b32 v121, v139, v138, 16
    v_mov_b32 v38, 50688
    v_mov_b32 v124, 0
    v_mov_b32 v125, 0
    v_mov_b32 v126, 0
    v_mov_b32 v127, 0
    s_waitcnt lgkmcnt(0)
    s_barrier
    ds_read_b128 v[60:63], v38
    ds_read_b128 v[64:67], v156 offset:38400
    ds_read_b128 v[68:71], v156 offset:41472
    ds_read_b128 v[72:75], v156 offset:44544
    ds_read_b128 v[76:79], v156 offset:47616
    ds_write_b128 v9, v[136:139] offset:32
    ds_write_b128 v9, v[134:137] offset:16656
    ds_write_b128 v9, v[100:103] offset:8336
    ds_write_b128 v9, v[102:105] offset:24976
    ds_write_b128 v9, v[108:111] offset:4176
    ds_write_b128 v9, v[110:113] offset:20816
    ds_write_b128 v9, v[116:119] offset:12496
    ds_write_b128 v9, v[118:121] offset:29136
    ds_write_b128 v11, v[124:127] offset:37888
    ds_write_b128 v10, v[124:127]
    s_waitcnt lgkmcnt(10)
    v_max_i32 v60, v60, v61
    v_max_i32 v62, v62, v63
    v_max_i32 v60, v60, v62
    v_max_i32 v60, -100, v60
    v_min_i32 v60, 100, v60
    v_sub_u32 v61, 133, v60
    v_lshlrev_b32 v61, 23, v61
    v_add_u32 v5, 121, v60
    v_lshlrev_b32 v5, 23, v5
    v_add_f32 v64, v64, v68
    v_add_f32 v72, v72, v76
    v_add_f32 v65, v65, v69
    v_add_f32 v73, v73, v77
    v_add_f32 v66, v66, v70
    v_add_f32 v74, v74, v78
    v_add_f32 v67, v67, v71
    v_add_f32 v75, v75, v79
    v_add_f32 v64, v64, v72
    v_add_f32 v65, v65, v73
    v_add_f32 v66, v66, v74
    v_add_f32 v67, v67, v75
    v_mul_f32 v64, v61, v64
    v_mul_f32 v65, v61, v65
    v_mul_f32 v66, v61, v66
    v_mul_f32 v67, v61, v67
    v_cvt_pk_f16_f32 v68, v64, v65
    v_cvt_pk_f16_f32 v69, v66, v67
    ds_write_b64 v155, v[68:69] offset:50752
    s_waitcnt lgkmcnt(0)
    s_barrier
    ds_read_u16 v56, v147 offset:50752
    ds_read_u16 v57, v148 offset:50752
    ds_read_u16 v58, v149 offset:50752
    ds_read_u16 v59, v150 offset:50752
    ds_read_u16 v60, v151 offset:50752
    ds_read_u16 v61, v152 offset:50752
    ds_read_u16 v62, v153 offset:50752
    ds_read_u16 v63, v154 offset:50752
    s_waitcnt lgkmcnt(0)
    v_lshl_or_b32 v40, v57, 16, v56
    v_lshl_or_b32 v41, v59, 16, v58
    v_lshl_or_b32 v42, v61, 16, v60
    v_lshl_or_b32 v43, v63, 16, v62
    ds_write_b128 v9, v[40:43] offset:33792
    s_waitcnt lgkmcnt(0)
    s_barrier
    ds_read_b128 v[80:83], v158 offset:4064
    ds_read_b128 v[76:79], v157 offset:3584
    ds_read_b128 v[72:75], v157 offset:3072
    ds_read_b128 v[68:71], v157 offset:2560
    ds_read_b128 v[64:67], v157 offset:2048
    ds_read_b128 v[60:63], v157 offset:1536
    ds_read_b128 v[56:59], v157 offset:1024
    ds_read_b128 v[52:55], v157 offset:512
    ds_read_b128 v[48:51], v157 offset:0
    ds_read_b128 v[84:87], v158 offset:3552
    ds_read_b128 v[88:91], v158 offset:3040
    ds_read_b128 v[92:95], v158 offset:2528
    ds_read_b128 v[96:99], v158 offset:2016
    ds_read_b128 v[100:103], v158 offset:1504
    ds_read_b128 v[104:107], v158 offset:992
    ds_read_b128 v[108:111], v158 offset:480
    s_waitcnt lgkmcnt(14)
    v_mfma_f32_16x16x32_f16 v[44:47], v[76:79], v[80:83], 0
    s_waitcnt lgkmcnt(13)
    v_mfma_f32_16x16x32_f16 v[40:43], v[72:75], v[80:83], 0
    s_waitcnt lgkmcnt(12)
    v_mfma_f32_16x16x32_f16 v[36:39], v[68:71], v[80:83], 0
    s_waitcnt lgkmcnt(11)
    v_mfma_f32_16x16x32_f16 v[32:35], v[64:67], v[80:83], 0
    s_waitcnt lgkmcnt(10)
    v_mfma_f32_16x16x32_f16 v[28:31], v[60:63], v[80:83], 0
    s_waitcnt lgkmcnt(9)
    v_mfma_f32_16x16x32_f16 v[24:27], v[56:59], v[80:83], 0
    s_waitcnt lgkmcnt(8)
    v_mfma_f32_16x16x32_f16 v[20:23], v[52:55], v[80:83], 0
    s_waitcnt lgkmcnt(7)
    v_mfma_f32_16x16x32_f16 v[16:19], v[48:51], v[80:83], 0
    ds_read_b128 v[80:83], v158 offset:4128
    ds_read_b128 v[76:79], v157 offset:3648
    s_waitcnt lgkmcnt(8)
    v_mfma_f32_16x16x32_f16 v[44:47], v[72:75], v[84:87], v[44:47]
    v_mfma_f32_16x16x32_f16 v[40:43], v[68:71], v[84:87], v[40:43]
    v_mfma_f32_16x16x32_f16 v[36:39], v[64:67], v[84:87], v[36:39]
    v_mfma_f32_16x16x32_f16 v[32:35], v[60:63], v[84:87], v[32:35]
    v_mfma_f32_16x16x32_f16 v[28:31], v[56:59], v[84:87], v[28:31]
    v_mfma_f32_16x16x32_f16 v[24:27], v[52:55], v[84:87], v[24:27]
    v_mfma_f32_16x16x32_f16 v[20:23], v[48:51], v[84:87], v[20:23]
    ds_read_b128 v[84:87], v158 offset:3616
    ds_read_b128 v[72:75], v157 offset:3136
    s_waitcnt lgkmcnt(9)
    v_mfma_f32_16x16x32_f16 v[44:47], v[68:71], v[88:91], v[44:47]
    v_mfma_f32_16x16x32_f16 v[40:43], v[64:67], v[88:91], v[40:43]
    v_mfma_f32_16x16x32_f16 v[36:39], v[60:63], v[88:91], v[36:39]
    v_mfma_f32_16x16x32_f16 v[32:35], v[56:59], v[88:91], v[32:35]
    v_mfma_f32_16x16x32_f16 v[28:31], v[52:55], v[88:91], v[28:31]
    v_mfma_f32_16x16x32_f16 v[24:27], v[48:51], v[88:91], v[24:27]
    ds_read_b128 v[88:91], v158 offset:3104
    ds_read_b128 v[68:71], v157 offset:2624
    s_waitcnt lgkmcnt(10)
    v_mfma_f32_16x16x32_f16 v[44:47], v[64:67], v[92:95], v[44:47]
    v_mfma_f32_16x16x32_f16 v[40:43], v[60:63], v[92:95], v[40:43]
    v_mfma_f32_16x16x32_f16 v[36:39], v[56:59], v[92:95], v[36:39]
    v_mfma_f32_16x16x32_f16 v[32:35], v[52:55], v[92:95], v[32:35]
    v_mfma_f32_16x16x32_f16 v[28:31], v[48:51], v[92:95], v[28:31]
    ds_read_b128 v[92:95], v158 offset:2592
    ds_read_b128 v[64:67], v157 offset:2112
    s_waitcnt lgkmcnt(11)
    v_mfma_f32_16x16x32_f16 v[44:47], v[60:63], v[96:99], v[44:47]
    v_mfma_f32_16x16x32_f16 v[40:43], v[56:59], v[96:99], v[40:43]
    v_mfma_f32_16x16x32_f16 v[36:39], v[52:55], v[96:99], v[36:39]
    v_mfma_f32_16x16x32_f16 v[32:35], v[48:51], v[96:99], v[32:35]
    ds_read_b128 v[96:99], v158 offset:2080
    ds_read_b128 v[60:63], v157 offset:1600
    s_waitcnt lgkmcnt(12)
    v_mfma_f32_16x16x32_f16 v[44:47], v[56:59], v[100:103], v[44:47]
    v_mfma_f32_16x16x32_f16 v[40:43], v[52:55], v[100:103], v[40:43]
    v_mfma_f32_16x16x32_f16 v[36:39], v[48:51], v[100:103], v[36:39]
    ds_read_b128 v[100:103], v158 offset:1568
    ds_read_b128 v[56:59], v157 offset:1088
    s_waitcnt lgkmcnt(13)
    v_mfma_f32_16x16x32_f16 v[44:47], v[52:55], v[104:107], v[44:47]
    v_mfma_f32_16x16x32_f16 v[40:43], v[48:51], v[104:107], v[40:43]
    ds_read_b128 v[104:107], v158 offset:1056
    ds_read_b128 v[52:55], v157 offset:576
    s_waitcnt lgkmcnt(14)
    v_mfma_f32_16x16x32_f16 v[44:47], v[48:51], v[108:111], v[44:47]
    ds_read_b128 v[108:111], v158 offset:544
    ds_read_b128 v[48:51], v157 offset:64
    s_waitcnt lgkmcnt(14)
    v_mfma_f32_16x16x32_f16 v[44:47], v[76:79], v[80:83], v[44:47]
    s_waitcnt lgkmcnt(12)
    v_mfma_f32_16x16x32_f16 v[40:43], v[72:75], v[80:83], v[40:43]
    s_waitcnt lgkmcnt(10)
    v_mfma_f32_16x16x32_f16 v[36:39], v[68:71], v[80:83], v[36:39]
    s_waitcnt lgkmcnt(8)
    v_mfma_f32_16x16x32_f16 v[32:35], v[64:67], v[80:83], v[32:35]
    s_waitcnt lgkmcnt(6)
    v_mfma_f32_16x16x32_f16 v[28:31], v[60:63], v[80:83], v[28:31]
    s_waitcnt lgkmcnt(4)
    v_mfma_f32_16x16x32_f16 v[24:27], v[56:59], v[80:83], v[24:27]
    s_waitcnt lgkmcnt(2)
    v_mfma_f32_16x16x32_f16 v[20:23], v[52:55], v[80:83], v[20:23]
    s_waitcnt lgkmcnt(0)
    v_mfma_f32_16x16x32_f16 v[16:19], v[48:51], v[80:83], v[16:19]
    v_mfma_f32_16x16x32_f16 v[44:47], v[72:75], v[84:87], v[44:47]
    v_mfma_f32_16x16x32_f16 v[40:43], v[68:71], v[84:87], v[40:43]
    v_mfma_f32_16x16x32_f16 v[36:39], v[64:67], v[84:87], v[36:39]
    v_mfma_f32_16x16x32_f16 v[32:35], v[60:63], v[84:87], v[32:35]
    v_mfma_f32_16x16x32_f16 v[28:31], v[56:59], v[84:87], v[28:31]
    v_mfma_f32_16x16x32_f16 v[24:27], v[52:55], v[84:87], v[24:27]
    v_mfma_f32_16x16x32_f16 v[20:23], v[48:51], v[84:87], v[20:23]
    v_mfma_f32_16x16x32_f16 v[44:47], v[68:71], v[88:91], v[44:47]
    v_mfma_f32_16x16x32_f16 v[40:43], v[64:67], v[88:91], v[40:43]
    v_mfma_f32_16x16x32_f16 v[36:39], v[60:63], v[88:91], v[36:39]
    v_mfma_f32_16x16x32_f16 v[32:35], v[56:59], v[88:91], v[32:35]
    v_mfma_f32_16x16x32_f16 v[28:31], v[52:55], v[88:91], v[28:31]
    v_mfma_f32_16x16x32_f16 v[24:27], v[48:51], v[88:91], v[24:27]
    v_mfma_f32_16x16x32_f16 v[44:47], v[64:67], v[92:95], v[44:47]
    v_mfma_f32_16x16x32_f16 v[40:43], v[60:63], v[92:95], v[40:43]
    v_mfma_f32_16x16x32_f16 v[36:39], v[56:59], v[92:95], v[36:39]
    v_mfma_f32_16x16x32_f16 v[32:35], v[52:55], v[92:95], v[32:35]
    v_mfma_f32_16x16x32_f16 v[28:31], v[48:51], v[92:95], v[28:31]
    v_mfma_f32_16x16x32_f16 v[44:47], v[60:63], v[96:99], v[44:47]
    v_mfma_f32_16x16x32_f16 v[40:43], v[56:59], v[96:99], v[40:43]
    v_mfma_f32_16x16x32_f16 v[36:39], v[52:55], v[96:99], v[36:39]
    v_mfma_f32_16x16x32_f16 v[32:35], v[48:51], v[96:99], v[32:35]
    v_mfma_f32_16x16x32_f16 v[44:47], v[56:59], v[100:103], v[44:47]
    v_mfma_f32_16x16x32_f16 v[40:43], v[52:55], v[100:103], v[40:43]
    v_mfma_f32_16x16x32_f16 v[36:39], v[48:51], v[100:103], v[36:39]
    v_mfma_f32_16x16x32_f16 v[44:47], v[52:55], v[104:107], v[44:47]
    v_mfma_f32_16x16x32_f16 v[40:43], v[48:51], v[104:107], v[40:43]
    v_mfma_f32_16x16x32_f16 v[44:47], v[48:51], v[108:111], v[44:47]
    s_nop 7
    s_barrier
    ds_write_b128 v159, v[16:19] offset:0
    ds_write_b128 v159, v[20:23] offset:1024
    ds_write_b128 v159, v[24:27] offset:2048
    ds_write_b128 v159, v[28:31] offset:3072
    ds_write_b128 v159, v[32:35] offset:4096
    ds_write_b128 v159, v[36:39] offset:5120
    ds_write_b128 v159, v[40:43] offset:6144
    ds_write_b128 v159, v[44:47] offset:7168
    s_bitcmp1_b32 s2, 0
    s_cbranch_scc1 L_m1_odd
    s_lshl_b32 s68, s68, 16
L_m1_odd:
    s_and_b32 s68, s68, 0xffff0000
    v_cvt_f32_f16 v48, v136
    v_cvt_f32_f16_sdwa v49, v136 dst_sel:DWORD dst_unused:UNUSED_PAD src0_sel:WORD_1
    v_cvt_f32_f16 v50, v137
    v_cvt_f32_f16_sdwa v51, v137 dst_sel:DWORD dst_unused:UNUSED_PAD src0_sel:WORD_1
    v_cvt_f32_f16 v52, v138
    v_cvt_f32_f16_sdwa v53, v138 dst_sel:DWORD dst_unused:UNUSED_PAD src0_sel:WORD_1
    v_cvt_f32_f16 v54, v139
    v_cvt_f32_f16_sdwa v55, v139 dst_sel:DWORD dst_unused:UNUSED_PAD src0_sel:WORD_1
    v_pk_mul_f32 v[48:49], v[48:49], s[68:69] op_sel_hi:[1,0]
    v_pk_mul_f32 v[50:51], v[50:51], s[68:69] op_sel_hi:[1,0]
    v_pk_mul_f32 v[52:53], v[52:53], s[68:69] op_sel_hi:[1,0]
    v_pk_mul_f32 v[54:55], v[54:55], s[68:69] op_sel_hi:[1,0]
    v_cvt_pk_bf16_f32 v56, v48, v49
    v_lshlrev_b32 v48, 16, v56
    v_and_b32 v49, 0xffff0000, v56
    v_cvt_pk_bf16_f32 v56, v50, v51
    v_lshlrev_b32 v50, 16, v56
    v_and_b32 v51, 0xffff0000, v56
    v_cvt_pk_bf16_f32 v56, v52, v53
    v_lshlrev_b32 v52, 16, v56
    v_and_b32 v53, 0xffff0000, v56
    v_cvt_pk_bf16_f32 v56, v54, v55
    v_lshlrev_b32 v54, 16, v56
    v_and_b32 v55, 0xffff0000, v56
    s_mov_b32 s22, 10368
    v_mul_lo_u32 v12, v0, s22
    s_lshl_b32 s23, s2, 4
    s_add_u32 s23, s23, 8388608
    s_waitcnt lgkmcnt(0)
    s_barrier
    ds_read_b128 v[16:19], v160 offset:0
    ds_read_b128 v[20:23], v160 offset:256
    ds_read_b128 v[24:27], v160 offset:8192
    ds_read_b128 v[28:31], v160 offset:8448
    ds_read_b128 v[32:35], v160 offset:16384
    ds_read_b128 v[36:39], v160 offset:16640
    ds_read_b128 v[40:43], v160 offset:24576
    ds_read_b128 v[44:47], v160 offset:24832
    s_waitcnt lgkmcnt(0)
    v_pk_add_f32 v[16:17], v[16:17], v[24:25]
    v_pk_add_f32 v[32:33], v[32:33], v[40:41]
    v_pk_add_f32 v[18:19], v[18:19], v[26:27]
    v_pk_add_f32 v[34:35], v[34:35], v[42:43]
    v_pk_add_f32 v[20:21], v[20:21], v[28:29]
    v_pk_add_f32 v[36:37], v[36:37], v[44:45]
    v_pk_add_f32 v[22:23], v[22:23], v[30:31]
    v_pk_add_f32 v[38:39], v[38:39], v[46:47]
    v_pk_add_f32 v[16:17], v[16:17], v[32:33]
    v_pk_add_f32 v[18:19], v[18:19], v[34:35]
    v_pk_add_f32 v[20:21], v[20:21], v[36:37]
    v_pk_add_f32 v[22:23], v[22:23], v[38:39]
    v_mul_f32 v16, v5, v16
    v_mul_f32 v17, v5, v17
    v_mul_f32 v18, v5, v18
    v_mul_f32 v19, v5, v19
    v_mul_f32 v20, v5, v20
    v_mul_f32 v21, v5, v21
    v_mul_f32 v22, v5, v22
    v_mul_f32 v23, v5, v23
    v_cvt_pk_bf16_f32 v56, v16, v17
    v_lshlrev_b32 v16, 16, v56
    v_and_b32 v17, 0xffff0000, v56
    v_cvt_pk_bf16_f32 v56, v18, v19
    v_lshlrev_b32 v18, 16, v56
    v_and_b32 v19, 0xffff0000, v56
    v_cvt_pk_bf16_f32 v56, v20, v21
    v_lshlrev_b32 v20, 16, v56
    v_and_b32 v21, 0xffff0000, v56
    v_cvt_pk_bf16_f32 v56, v22, v23
    v_lshlrev_b32 v22, 16, v56
    v_and_b32 v23, 0xffff0000, v56
    v_pk_add_f32 v[16:17], v[16:17], v[48:49]
    v_pk_add_f32 v[18:19], v[18:19], v[50:51]
    v_pk_add_f32 v[20:21], v[20:21], v[52:53]
    v_pk_add_f32 v[22:23], v[22:23], v[54:55]
    v_cvt_pk_bf16_f32 v60, v16, v17
    v_cvt_pk_bf16_f32 v61, v18, v19
    v_cvt_pk_bf16_f32 v62, v20, v21
    v_cvt_pk_bf16_f32 v63, v22, v23
    buffer_store_dwordx4 v[60:63], v12, s[12:15], s23 offen
L_m1_done:
    s_endpgm
.globl tail_kernel
.p2align 8
.type tail_kernel,@function
tail_kernel:
    s_cmp_ge_u32 s2, 256
    s_cbranch_scc1 L_t_done
    s_load_dwordx2 s[4:5], s[0:1], 0
    s_load_dwordx4 s[36:39], s[0:1], 80
    s_load_dwordx4 s[48:51], s[0:1], 96
    s_load_dwordx2 s[52:53], s[0:1], 112
    s_load_dwordx2 s[6:7], s[0:1], 128
    v_lshrrev_b32 v1, 6, v0
    v_and_b32 v2, 63, v0
    s_nop 0
    v_readfirstlane_b32 s3, v1
    s_and_b32 s57, s2, 7
    s_mul_i32 s57, s57, 24
    s_lshr_b32 s56, s2, 3
    s_add_u32 s56, s56, s57
    s_waitcnt lgkmcnt(0)
    s_cmp_ge_u32 s3, 2
    s_cselect_b32 s38, s48, s38
    s_cselect_b32 s39, s49, s39
    s_mov_b32 s8, s4
    s_mov_b32 s9, s5
    s_mov_b32 s10, 2621440
    s_mov_b32 s11, 0x00020000
    s_mov_b32 s12, s6
    s_mov_b32 s13, s7
    s_mov_b32 s14, 268435456
    s_mov_b32 s15, 0x00020000
    s_mov_b32 s40, s36
    s_mov_b32 s41, s37
    s_mov_b32 s42, 1280
    s_mov_b32 s43, 0x00020000
    s_mov_b32 s44, s52
    s_mov_b32 s45, s53
    s_mov_b32 s46, 2621440
    s_mov_b32 s47, 0x00020000
    s_mov_b32 s60, s38
    s_mov_b32 s61, s39
    s_mov_b32 s62, 1966080
    s_mov_b32 s63, 0x00020000
    s_mov_b32 s64, s50
    s_mov_b32 s65, s51
    s_mov_b32 s66, 1966080
    s_mov_b32 s67, 0x00020000
    s_lshl_b32 s16, s2, 3
    s_lshl_b32 s17, s3, 1
    s_add_u32 s16, s16, s17
    s_mul_i32 s17, s16, 1280
    v_lshlrev_b32 v3, 2, v2
    s_mul_i32 s18, s2, 10368
    s_add_u32 s18, s18, 8388608
    s_lshl_b32 s19, s3, 2
    s_add_u32 s18, s18, s19
    s_add_u32 s19, s18, 4096
    s_add_u32 s34, s18, 8192
    v_lshlrev_b32 v4, 5, v2
    buffer_load_dword v6, v3, s[8:11], s17 offen offset:0
    buffer_load_dword v7, v3, s[8:11], s17 offen offset:256
    buffer_load_dword v8, v3, s[8:11], s17 offen offset:512
    buffer_load_dword v9, v3, s[8:11], s17 offen offset:768
    buffer_load_dword v10, v3, s[8:11], s17 offen offset:1024
    buffer_load_dword v11, v3, s[8:11], s17 offen offset:1280
    buffer_load_dword v12, v3, s[8:11], s17 offen offset:1536
    buffer_load_dword v13, v3, s[8:11], s17 offen offset:1792
    buffer_load_dword v14, v3, s[8:11], s17 offen offset:2048
    buffer_load_dword v15, v3, s[8:11], s17 offen offset:2304
    buffer_load_dword v16, v4, s[12:15], s18 offen offset:0
    buffer_load_dword v17, v4, s[12:15], s18 offen offset:16
    buffer_load_dword v18, v4, s[12:15], s18 offen offset:2048
    buffer_load_dword v19, v4, s[12:15], s18 offen offset:2064
    buffer_load_dword v20, v4, s[12:15], s19 offen offset:0
    buffer_load_dword v21, v4, s[12:15], s19 offen offset:16
    buffer_load_dword v22, v4, s[12:15], s19 offen offset:2048
    buffer_load_dword v23, v4, s[12:15], s19 offen offset:2064
    buffer_load_dword v24, v4, s[12:15], s34 offen offset:0
    buffer_load_dword v25, v4, s[12:15], s34 offen offset:16
    buffer_load_dword v26, v3, s[40:43], 0 offen offset:0
    buffer_load_dword v27, v3, s[40:43], 0 offen offset:256
    buffer_load_dword v28, v3, s[40:43], 0 offen offset:512
    buffer_load_dword v29, v3, s[40:43], 0 offen offset:768
    buffer_load_dword v30, v3, s[40:43], 0 offen offset:1024
    s_mov_b32 s68, 0x3acccccd
    s_mov_b32 s70, 0x3727c5ac
    s_waitcnt vmcnt(0)
    v_lshlrev_b32 v52, 16, v16
    v_and_b32 v53, 0xffff0000, v16
    v_lshlrev_b32 v32, 16, v6
    v_lshlrev_b32 v33, 16, v11
    v_pk_add_f32 v[32:33], v[32:33], v[52:53]
    v_cvt_pk_bf16_f32 v54, v32, v33
    v_lshlrev_b32 v32, 16, v54
    v_and_b32 v33, 0xffff0000, v54
    v_lshlrev_b32 v52, 16, v17
    v_and_b32 v53, 0xffff0000, v17
    v_and_b32 v34, 0xffff0000, v6
    v_and_b32 v35, 0xffff0000, v11
    v_pk_add_f32 v[34:35], v[34:35], v[52:53]
    v_cvt_pk_bf16_f32 v54, v34, v35
    v_lshlrev_b32 v34, 16, v54
    v_and_b32 v35, 0xffff0000, v54
    v_lshlrev_b32 v52, 16, v18
    v_and_b32 v53, 0xffff0000, v18
    v_lshlrev_b32 v36, 16, v7
    v_lshlrev_b32 v37, 16, v12
    v_pk_add_f32 v[36:37], v[36:37], v[52:53]
    v_cvt_pk_bf16_f32 v54, v36, v37
    v_lshlrev_b32 v36, 16, v54
    v_and_b32 v37, 0xffff0000, v54
    v_lshlrev_b32 v52, 16, v19
    v_and_b32 v53, 0xffff0000, v19
    v_and_b32 v38, 0xffff0000, v7
    v_and_b32 v39, 0xffff0000, v12
    v_pk_add_f32 v[38:39], v[38:39], v[52:53]
    v_cvt_pk_bf16_f32 v54, v38, v39
    v_lshlrev_b32 v38, 16, v54
    v_and_b32 v39, 0xffff0000, v54
    v_lshlrev_b32 v52, 16, v20
    v_and_b32 v53, 0xffff0000, v20
    v_lshlrev_b32 v40, 16, v8
    v_lshlrev_b32 v41, 16, v13
    v_pk_add_f32 v[40:41], v[40:41], v[52:53]
    v_cvt_pk_bf16_f32 v54, v40, v41
    v_lshlrev_b32 v40, 16, v54
    v_and_b32 v41, 0xffff0000, v54
    v_lshlrev_b32 v52, 16, v21
    v_and_b32 v53, 0xffff0000, v21
    v_and_b32 v42, 0xffff0000, v8
    v_and_b32 v43, 0xffff0000, v13
    v_pk_add_f32 v[42:43], v[42:43], v[52:53]
    v_cvt_pk_bf16_f32 v54, v42, v43
    v_lshlrev_b32 v42, 16, v54
    v_and_b32 v43, 0xffff0000, v54
    v_lshlrev_b32 v52, 16, v22
    v_and_b32 v53, 0xffff0000, v22
    v_lshlrev_b32 v44, 16, v9
    v_lshlrev_b32 v45, 16, v14
    v_pk_add_f32 v[44:45], v[44:45], v[52:53]
    v_cvt_pk_bf16_f32 v54, v44, v45
    v_lshlrev_b32 v44, 16, v54
    v_and_b32 v45, 0xffff0000, v54
    v_lshlrev_b32 v52, 16, v23
    v_and_b32 v53, 0xffff0000, v23
    v_and_b32 v46, 0xffff0000, v9
    v_and_b32 v47, 0xffff0000, v14
    v_pk_add_f32 v[46:47], v[46:47], v[52:53]
    v_cvt_pk_bf16_f32 v54, v46, v47
    v_lshlrev_b32 v46, 16, v54
    v_and_b32 v47, 0xffff0000, v54
    v_lshlrev_b32 v52, 16, v24
    v_and_b32 v53, 0xffff0000, v24
    v_lshlrev_b32 v48, 16, v10
    v_lshlrev_b32 v49, 16, v15
    v_pk_add_f32 v[48:49], v[48:49], v[52:53]
    v_cvt_pk_bf16_f32 v54, v48, v49
    v_lshlrev_b32 v48, 16, v54
    v_and_b32 v49, 0xffff0000, v54
    v_lshlrev_b32 v52, 16, v25
    v_and_b32 v53, 0xffff0000, v25
    v_and_b32 v50, 0xffff0000, v10
    v_and_b32 v51, 0xffff0000, v15
    v_pk_add_f32 v[50:51], v[50:51], v[52:53]
    v_cvt_pk_bf16_f32 v54, v50, v51
    v_lshlrev_b32 v50, 16, v54
    v_and_b32 v51, 0xffff0000, v54
    v_pk_add_f32 v[52:53], v[32:33], v[34:35]
    v_pk_add_f32 v[54:55], v[36:37], v[38:39]
    v_pk_add_f32 v[52:53], v[52:53], v[40:41]
    v_pk_add_f32 v[54:55], v[54:55], v[42:43]
    v_pk_add_f32 v[52:53], v[52:53], v[44:45]
    v_pk_add_f32 v[54:55], v[54:55], v[46:47]
    v_pk_add_f32 v[52:53], v[52:53], v[48:49]
    v_pk_add_f32 v[54:55], v[54:55], v[50:51]
    v_pk_add_f32 v[52:53], v[52:53], v[54:55]
    s_nop 1
    v_add_f32_dpp v52, v52, v52 row_shr:1 row_mask:0xf bank_mask:0xf
    v_add_f32_dpp v53, v53, v53 row_shr:1 row_mask:0xf bank_mask:0xf
    s_nop 0
    v_add_f32_dpp v52, v52, v52 row_shr:2 row_mask:0xf bank_mask:0xf
    v_add_f32_dpp v53, v53, v53 row_shr:2 row_mask:0xf bank_mask:0xf
    s_nop 0
    v_add_f32_dpp v52, v52, v52 row_shr:4 row_mask:0xf bank_mask:0xf
    v_add_f32_dpp v53, v53, v53 row_shr:4 row_mask:0xf bank_mask:0xf
    s_nop 0
    v_add_f32_dpp v52, v52, v52 row_shr:8 row_mask:0xf bank_mask:0xf
    v_add_f32_dpp v53, v53, v53 row_shr:8 row_mask:0xf bank_mask:0xf
    s_nop 0
    v_add_f32_dpp v52, v52, v52 row_bcast:15 row_mask:0xa bank_mask:0xf
    v_add_f32_dpp v53, v53, v53 row_bcast:15 row_mask:0xa bank_mask:0xf
    s_nop 0
    v_add_f32_dpp v52, v52, v52 row_bcast:31 row_mask:0xc bank_mask:0xf
    v_add_f32_dpp v53, v53, v53 row_bcast:31 row_mask:0xc bank_mask:0xf
    s_nop 0
    s_nop 0
    v_pk_mul_f32 v[52:53], v[52:53], s[68:69] op_sel_hi:[1,0]
    s_nop 0
    v_readlane_b32 s20, v52, 63
    v_readlane_b32 s21, v53, 63
    v_cvt_pk_bf16_f32 v54, v52, v53
    v_lshlrev_b32 v52, 16, v54
    v_and_b32 v53, 0xffff0000, v54
    s_nop 0
    v_readlane_b32 s24, v52, 63
    v_readlane_b32 s25, v53, 63
    v_pk_add_f32 v[54:55], v[32:33], s[20:21] neg_lo:[0,1] neg_hi:[0,1]
    v_pk_mul_f32 v[52:53], v[54:55], v[54:55]
    v_pk_add_f32 v[54:55], v[34:35], s[20:21] neg_lo:[0,1] neg_hi:[0,1]
    v_pk_fma_f32 v[52:53], v[54:55], v[54:55], v[52:53]
    v_pk_add_f32 v[54:55], v[36:37], s[20:21] neg_lo:[0,1] neg_hi:[0,1]
    v_pk_fma_f32 v[52:53], v[54:55], v[54:55], v[52:53]
    v_pk_add_f32 v[54:55], v[38:39], s[20:21] neg_lo:[0,1] neg_hi:[0,1]
    v_pk_fma_f32 v[52:53], v[54:55], v[54:55], v[52:53]
    v_pk_add_f32 v[54:55], v[40:41], s[20:21] neg_lo:[0,1] neg_hi:[0,1]
    v_pk_fma_f32 v[52:53], v[54:55], v[54:55], v[52:53]
    v_pk_add_f32 v[54:55], v[42:43], s[20:21] neg_lo:[0,1] neg_hi:[0,1]
    v_pk_fma_f32 v[52:53], v[54:55], v[54:55], v[52:53]
    v_pk_add_f32 v[54:55], v[44:45], s[20:21] neg_lo:[0,1] neg_hi:[0,1]
    v_pk_fma_f32 v[52:53], v[54:55], v[54:55], v[52:53]
    v_pk_add_f32 v[54:55], v[46:47], s[20:21] neg_lo:[0,1] neg_hi:[0,1]
    v_pk_fma_f32 v[52:53], v[54:55], v[54:55], v[52:53]
    v_pk_add_f32 v[54:55], v[48:49], s[20:21] neg_lo:[0,1] neg_hi:[0,1]
    v_pk_fma_f32 v[52:53], v[54:55], v[54:55], v[52:53]
    v_pk_add_f32 v[54:55], v[50:51], s[20:21] neg_lo:[0,1] neg_hi:[0,1]
    v_pk_fma_f32 v[52:53], v[54:55], v[54:55], v[52:53]
    s_nop 1
    v_add_f32_dpp v52, v52, v52 row_shr:1 row_mask:0xf bank_mask:0xf
    v_add_f32_dpp v53, v53, v53 row_shr:1 row_mask:0xf bank_mask:0xf
    s_nop 0
    v_add_f32_dpp v52, v52, v52 row_shr:2 row_mask:0xf bank_mask:0xf
    v_add_f32_dpp v53, v53, v53 row_shr:2 row_mask:0xf bank_mask:0xf
    s_nop 0
    v_add_f32_dpp v52, v52, v52 row_shr:4 row_mask:0xf bank_mask:0xf
    v_add_f32_dpp v53, v53, v53 row_shr:4 row_mask:0xf bank_mask:0xf
    s_nop 0
    v_add_f32_dpp v52, v52, v52 row_shr:8 row_mask:0xf bank_mask:0xf
    v_add_f32_dpp v53, v53, v53 row_shr:8 row_mask:0xf bank_mask:0xf
    s_nop 0
    v_add_f32_dpp v52, v52, v52 row_bcast:15 row_mask:0xa bank_mask:0xf
    v_add_f32_dpp v53, v53, v53 row_bcast:15 row_mask:0xa bank_mask:0xf
    s_nop 0
    v_add_f32_dpp v52, v52, v52 row_bcast:31 row_mask:0xc bank_mask:0xf
    v_add_f32_dpp v53, v53, v53 row_bcast:31 row_mask:0xc bank_mask:0xf
    s_nop 0
    s_nop 0
    v_pk_mul_f32 v[52:53], v[52:53], s[68:69] op_sel_hi:[1,0]
    v_cvt_pk_bf16_f32 v54, v52, v53
    v_lshlrev_b32 v52, 16, v54
    v_and_b32 v53, 0xffff0000, v54
    v_pk_add_f32 v[52:53], v[52:53], s[70:71] op_sel_hi:[1,0]
    v_cvt_pk_bf16_f32 v54, v52, v53
    v_lshlrev_b32 v52, 16, v54
    v_and_b32 v53, 0xffff0000, v54
    v_sqrt_f32 v52, v52
    v_sqrt_f32 v53, v53
    s_nop 0
    v_cvt_pk_bf16_f32 v54, v52, v53
    v_lshlrev_b32 v52, 16, v54
    v_and_b32 v53, 0xffff0000, v54
    v_rcp_f32 v52, v52
    v_rcp_f32 v53, v53
    s_nop 0
    v_readlane_b32 s28, v52, 63
    v_readlane_b32 s29, v53, 63
    s_nop 1
    v_pk_add_f32 v[56:57], v[32:33], s[24:25] neg_lo:[0,1] neg_hi:[0,1]
    v_cvt_pk_bf16_f32 v54, v56, v57
    v_lshlrev_b32 v56, 16, v54
    v_and_b32 v57, 0xffff0000, v54
    v_pk_mul_f32 v[56:57], v[56:57], s[28:29]
    v_cvt_pk_bf16_f32 v54, v56, v57
    v_lshlrev_b32 v56, 16, v54
    v_and_b32 v57, 0xffff0000, v54
    v_lshlrev_b32 v76, 16, v26
    v_pk_mul_f32 v[52:53], v[56:57], v[76:77] op_sel_hi:[1,0]
    v_pk_add_f32 v[58:59], v[34:35], s[24:25] neg_lo:[0,1] neg_hi:[0,1]
    v_cvt_pk_bf16_f32 v54, v58, v59
    v_lshlrev_b32 v58, 16, v54
    v_and_b32 v59, 0xffff0000, v54
    v_pk_mul_f32 v[58:59], v[58:59], s[28:29]
    v_cvt_pk_bf16_f32 v54, v58, v59
    v_lshlrev_b32 v58, 16, v54
    v_and_b32 v59, 0xffff0000, v54
    v_and_b32 v76, 0xffff0000, v26
    v_pk_fma_f32 v[52:53], v[58:59], v[76:77], v[52:53] op_sel_hi:[1,0,1]
    v_pk_add_f32 v[60:61], v[36:37], s[24:25] neg_lo:[0,1] neg_hi:[0,1]
    v_cvt_pk_bf16_f32 v54, v60, v61
    v_lshlrev_b32 v60, 16, v54
    v_and_b32 v61, 0xffff0000, v54
    v_pk_mul_f32 v[60:61], v[60:61], s[28:29]
    v_cvt_pk_bf16_f32 v54, v60, v61
    v_lshlrev_b32 v60, 16, v54
    v_and_b32 v61, 0xffff0000, v54
    v_lshlrev_b32 v76, 16, v27
    v_pk_fma_f32 v[52:53], v[60:61], v[76:77], v[52:53] op_sel_hi:[1,0,1]
    v_pk_add_f32 v[62:63], v[38:39], s[24:25] neg_lo:[0,1] neg_hi:[0,1]
    v_cvt_pk_bf16_f32 v54, v62, v63
    v_lshlrev_b32 v62, 16, v54
    v_and_b32 v63, 0xffff0000, v54
    v_pk_mul_f32 v[62:63], v[62:63], s[28:29]
    v_cvt_pk_bf16_f32 v54, v62, v63
    v_lshlrev_b32 v62, 16, v54
    v_and_b32 v63, 0xffff0000, v54
    v_and_b32 v76, 0xffff0000, v27
    v_pk_fma_f32 v[52:53], v[62:63], v[76:77], v[52:53] op_sel_hi:[1,0,1]
    v_pk_add_f32 v[64:65], v[40:41], s[24:25] neg_lo:[0,1] neg_hi:[0,1]
    v_cvt_pk_bf16_f32 v54, v64, v65
    v_lshlrev_b32 v64, 16, v54
    v_and_b32 v65, 0xffff0000, v54
    v_pk_mul_f32 v[64:65], v[64:65], s[28:29]
    v_cvt_pk_bf16_f32 v54, v64, v65
    v_lshlrev_b32 v64, 16, v54
    v_and_b32 v65, 0xffff0000, v54
    v_lshlrev_b32 v76, 16, v28
    v_pk_fma_f32 v[52:53], v[64:65], v[76:77], v[52:53] op_sel_hi:[1,0,1]
    v_pk_add_f32 v[66:67], v[42:43], s[24:25] neg_lo:[0,1] neg_hi:[0,1]
    v_cvt_pk_bf16_f32 v54, v66, v67
    v_lshlrev_b32 v66, 16, v54
    v_and_b32 v67, 0xffff0000, v54
    v_pk_mul_f32 v[66:67], v[66:67], s[28:29]
    v_cvt_pk_bf16_f32 v54, v66, v67
    v_lshlrev_b32 v66, 16, v54
    v_and_b32 v67, 0xffff0000, v54
    v_and_b32 v76, 0xffff0000, v28
    v_pk_fma_f32 v[52:53], v[66:67], v[76:77], v[52:53] op_sel_hi:[1,0,1]
    v_pk_add_f32 v[68:69], v[44:45], s[24:25] neg_lo:[0,1] neg_hi:[0,1]
    v_cvt_pk_bf16_f32 v54, v68, v69
    v_lshlrev_b32 v68, 16, v54
    v_and_b32 v69, 0xffff0000, v54
    v_pk_mul_f32 v[68:69], v[68:69], s[28:29]
    v_cvt_pk_bf16_f32 v54, v68, v69
    v_lshlrev_b32 v68, 16, v54
    v_and_b32 v69, 0xffff0000, v54
    v_lshlrev_b32 v76, 16, v29
    v_pk_fma_f32 v[52:53], v[68:69], v[76:77], v[52:53] op_sel_hi:[1,0,1]
    v_pk_add_f32 v[70:71], v[46:47], s[24:25] neg_lo:[0,1] neg_hi:[0,1]
    v_cvt_pk_bf16_f32 v54, v70, v71
    v_lshlrev_b32 v70, 16, v54
    v_and_b32 v71, 0xffff0000, v54
    v_pk_mul_f32 v[70:71], v[70:71], s[28:29]
    v_cvt_pk_bf16_f32 v54, v70, v71
    v_lshlrev_b32 v70, 16, v54
    v_and_b32 v71, 0xffff0000, v54
    v_and_b32 v76, 0xffff0000, v29
    v_pk_fma_f32 v[52:53], v[70:71], v[76:77], v[52:53] op_sel_hi:[1,0,1]
    v_pk_add_f32 v[72:73], v[48:49], s[24:25] neg_lo:[0,1] neg_hi:[0,1]
    v_cvt_pk_bf16_f32 v54, v72, v73
    v_lshlrev_b32 v72, 16, v54
    v_and_b32 v73, 0xffff0000, v54
    v_pk_mul_f32 v[72:73], v[72:73], s[28:29]
    v_cvt_pk_bf16_f32 v54, v72, v73
    v_lshlrev_b32 v72, 16, v54
    v_and_b32 v73, 0xffff0000, v54
    v_lshlrev_b32 v76, 16, v30
    v_pk_fma_f32 v[52:53], v[72:73], v[76:77], v[52:53] op_sel_hi:[1,0,1]
    v_pk_add_f32 v[74:75], v[50:51], s[24:25] neg_lo:[0,1] neg_hi:[0,1]
    v_cvt_pk_bf16_f32 v54, v74, v75
    v_lshlrev_b32 v74, 16, v54
    v_and_b32 v75, 0xffff0000, v54
    v_pk_mul_f32 v[74:75], v[74:75], s[28:29]
    v_cvt_pk_bf16_f32 v54, v74, v75
    v_lshlrev_b32 v74, 16, v54
    v_and_b32 v75, 0xffff0000, v54
    v_and_b32 v76, 0xffff0000, v30
    v_pk_fma_f32 v[52:53], v[74:75], v[76:77], v[52:53] op_sel_hi:[1,0,1]
    s_nop 1
    v_add_f32_dpp v52, v52, v52 row_shr:1 row_mask:0xf bank_mask:0xf
    v_add_f32_dpp v53, v53, v53 row_shr:1 row_mask:0xf bank_mask:0xf
    s_nop 0
    v_add_f32_dpp v52, v52, v52 row_shr:2 row_mask:0xf bank_mask:0xf
    v_add_f32_dpp v53, v53, v53 row_shr:2 row_mask:0xf bank_mask:0xf
    s_nop 0
    v_add_f32_dpp v52, v52, v52 row_shr:4 row_mask:0xf bank_mask:0xf
    v_add_f32_dpp v53, v53, v53 row_shr:4 row_mask:0xf bank_mask:0xf
    s_nop 0
    v_add_f32_dpp v52, v52, v52 row_shr:8 row_mask:0xf bank_mask:0xf
    v_add_f32_dpp v53, v53, v53 row_shr:8 row_mask:0xf bank_mask:0xf
    s_nop 0
    v_add_f32_dpp v52, v52, v52 row_bcast:15 row_mask:0xa bank_mask:0xf
    v_add_f32_dpp v53, v53, v53 row_bcast:15 row_mask:0xa bank_mask:0xf
    s_nop 0
    v_add_f32_dpp v52, v52, v52 row_bcast:31 row_mask:0xc bank_mask:0xf
    v_add_f32_dpp v53, v53, v53 row_bcast:31 row_mask:0xc bank_mask:0xf
    s_nop 0
    s_nop 0
    v_cvt_pk_bf16_f32 v52, v52, v53
    s_nop 0
    v_readlane_b32 s20, v52, 63
    v_pk_add_f32 v[56:57], v[56:57], v[32:33]
    v_pk_add_f32 v[58:59], v[58:59], v[34:35]
    v_pk_add_f32 v[60:61], v[60:61], v[36:37]
    v_pk_add_f32 v[62:63], v[62:63], v[38:39]
    v_pk_add_f32 v[64:65], v[64:65], v[40:41]
    v_pk_add_f32 v[66:67], v[66:67], v[42:43]
    v_pk_add_f32 v[68:69], v[68:69], v[44:45]
    v_pk_add_f32 v[70:71], v[70:71], v[46:47]
    v_pk_add_f32 v[72:73], v[72:73], v[48:49]
    v_pk_add_f32 v[74:75], v[74:75], v[50:51]
    v_cvt_pk_bf16_f32 v6, v56, v58
    v_cvt_pk_bf16_f32 v7, v60, v62
    v_cvt_pk_bf16_f32 v8, v64, v66
    v_cvt_pk_bf16_f32 v9, v68, v70
    v_cvt_pk_bf16_f32 v10, v72, v74
    v_cvt_pk_bf16_f32 v11, v57, v59
    v_cvt_pk_bf16_f32 v12, v61, v63
    v_cvt_pk_bf16_f32 v13, v65, v67
    v_cvt_pk_bf16_f32 v14, v69, v71
    v_cvt_pk_bf16_f32 v15, v73, v75
    s_and_b32 s21, s20, 0xffff
    s_lshr_b32 s22, s20, 16
    s_xor_b32 s23, s21, 0xffff
    s_or_b32 s24, s21, 0x8000
    s_bitcmp1_b32 s21, 15
    s_cselect_b32 s21, s23, s24
    s_xor_b32 s23, s22, 0xffff
    s_or_b32 s24, s22, 0x8000
    s_bitcmp1_b32 s22, 15
    s_cselect_b32 s22, s23, s24
    s_lshl_b32 s21, s21, 16
    s_lshl_b32 s22, s22, 16
    s_sub_u32 s23, 0xffff, s16
    s_or_b32 s21, s21, s23
    s_sub_u32 s23, s23, 1
    s_or_b32 s22, s22, s23
    s_max_u32 s23, s21, s22
    v_mov_b32 v52, s23
    s_lshl_b32 s24, s3, 2
    v_mov_b32 v53, s24
    ds_write_b32 v53, v52
    v_mov_b32 v53, 0
    s_waitcnt lgkmcnt(0)
    s_barrier
    ds_read_b128 v[76:79], v53
    s_lshl_b32 s25, s2, 2
    s_add_u32 s25, s25, 12582912
    s_waitcnt lgkmcnt(0)
    v_max_u32 v76, v76, v77
    v_max_u32 v78, v78, v79
    v_max_u32 v76, v76, v78
    s_cmp_lg_u32 s3, 0
    s_cbranch_scc1 L_t_nokey
    v_cmp_eq_u32 vcc, 0, v2
    s_and_saveexec_b64 s[30:31], vcc
    buffer_store_dword v76, v53, s[12:15], s25 offen sc1
    s_mov_b64 exec, s[30:31]
L_t_nokey:
    v_readfirstlane_b32 s24, v76
    s_nop 3
    s_mov_b32 s26, 0
    s_cmp_eq_u32 s24, s21
    s_cselect_b32 s26, 1, s26
    s_cmp_eq_u32 s24, s22
    s_cselect_b32 s26, 2, s26
    s_cmp_eq_u32 s26, 1
    s_cbranch_scc1 L_t_skip0
    buffer_store_dword v6, v3, s[44:47], s17 offen offset:0
    buffer_store_dword v7, v3, s[44:47], s17 offen offset:256
    buffer_store_dword v8, v3, s[44:47], s17 offen offset:512
    buffer_store_dword v9, v3, s[44:47], s17 offen offset:768
    buffer_store_dword v10, v3, s[44:47], s17 offen offset:1024
L_t_skip0:
    s_cmp_eq_u32 s26, 2
    s_cbranch_scc1 L_t_skip1
    buffer_store_dword v11, v3, s[44:47], s17 offen offset:1280
    buffer_store_dword v12, v3, s[44:47], s17 offen offset:1536
    buffer_store_dword v13, v3, s[44:47], s17 offen offset:1792
    buffer_store_dword v14, v3, s[44:47], s17 offen offset:2048
    buffer_store_dword v15, v3, s[44:47], s17 offen offset:2304
L_t_skip1:
    v_and_b32 v116, 127, v0
    s_cmp_ge_u32 s2, 192
    s_cbranch_scc1 L_t_wd
    s_movk_i32 s21, 3072
    v_mul_lo_u32 v117, v116, s21
    s_lshl_b32 s22, s56, 4
    buffer_load_dwordx4 v[80:83], v117, s[60:63], s22 offen
    s_add_u32 s22, s22, 393216
    buffer_load_dwordx4 v[84:87], v117, s[60:63], s22 offen
    s_add_u32 s22, s22, 393216
    buffer_load_dwordx4 v[88:91], v117, s[60:63], s22 offen
    s_add_u32 s22, s22, 393216
    buffer_load_dwordx4 v[92:95], v117, s[60:63], s22 offen
    s_add_u32 s22, s22, 393216
    buffer_load_dwordx4 v[96:99], v117, s[60:63], s22 offen
    s_branch L_t_wdone
L_t_wd:
    s_movk_i32 s21, 1280
    v_mul_lo_u32 v117, v0, s21
    s_sub_u32 s56, s2, 192
    s_and_b32 s22, s56, 7
    s_lshl_b32 s22, s22, 3
    s_lshr_b32 s56, s56, 3
    s_add_u32 s56, s56, s22
    s_mul_i32 s22, s56, 20
    s_cmp_eq_u32 s3, 3
    s_cbranch_scc1 L_t_wdone
    buffer_load_dwordx4 v[80:83], v117, s[64:67], s22 offen
    buffer_load_dword v84, v117, s[64:67], s22 offen offset:16
    s_add_u32 s22, s22, 327680
    buffer_load_dwordx4 v[86:89], v117, s[64:67], s22 offen
    buffer_load_dword v90, v117, s[64:67], s22 offen offset:16
    s_add_u32 s22, s22, 327680
    buffer_load_dwordx4 v[92:95], v117, s[64:67], s22 offen
    buffer_load_dword v96, v117, s[64:67], s22 offen offset:16
    s_add_u32 s22, s22, 327680
    buffer_load_dwordx4 v[98:101], v117, s[64:67], s22 offen
    buffer_load_dword v102, v117, s[64:67], s22 offen offset:16
    s_add_u32 s22, s22, 327680
    buffer_load_dwordx4 v[104:107], v117, s[64:67], s22 offen
    buffer_load_dword v108, v117, s[64:67], s22 offen offset:16
    s_add_u32 s22, s22, 327680
    buffer_load_dwordx4 v[110:113], v117, s[64:67], s22 offen
    buffer_load_dword v114, v117, s[64:67], s22 offen offset:16
L_t_wdone:
    s_cmp_lg_u32 s3, 3
    s_cbranch_scc1 L_t_wait
    v_lshlrev_b32 v120, 4, v2
    s_mov_b32 s27, 12582912
    s_mov_b32 s58, 0
L_t_poll:
    buffer_load_dwordx4 v[76:79], v120, s[12:15], s27 offen sc1
    s_waitcnt vmcnt(0)
    v_min_u32 v121, v76, v77
    v_min_u32 v122, v78, v79
    v_min_u32 v121, v121, v122
    v_cmp_eq_u32 s[30:31], 0, v121
    v_max_u32 v76, v76, v77
    v_max_u32 v78, v78, v79
    v_max_u32 v76, v76, v78
    s_nop 1
    v_max_u32_dpp v76, v76, v76 row_shr:1 row_mask:0xf bank_mask:0xf
    s_nop 1
    v_max_u32_dpp v76, v76, v76 row_shr:2 row_mask:0xf bank_mask:0xf
    s_nop 1
    v_max_u32_dpp v76, v76, v76 row_shr:4 row_mask:0xf bank_mask:0xf
    s_nop 1
    v_max_u32_dpp v76, v76, v76 row_shr:8 row_mask:0xf bank_mask:0xf
    s_nop 1
    v_max_u32_dpp v76, v76, v76 row_bcast:15 row_mask:0xa bank_mask:0xf
    s_nop 1
    v_max_u32_dpp v76, v76, v76 row_bcast:31 row_mask:0xc bank_mask:0xf
    s_nop 1
    s_nop 0
    v_readlane_b32 s20, v76, 63
    s_nop 3
    s_cmp_eq_u32 s20, s58
    s_cbranch_scc0 L_t_fetch
    s_cmp_eq_u64 s[30:31], 0
    s_cbranch_scc1 L_t_have
    s_sleep 1
    s_branch L_t_poll
L_t_fetch:
    s_mov_b32 s58, s20
    s_and_b32 s21, s20, 0xffff
    s_sub_u32 s21, 0xffff, s21
    s_mul_i32 s59, s21, 1280
    s_lshr_b32 s28, s21, 3
    s_mul_i32 s28, s28, 10368
    s_add_u32 s28, s28, 8388608
    s_and_b32 s29, s21, 7
    s_lshl_b32 s29, s29, 1
    s_add_u32 s28, s28, s29
    s_add_u32 s29, s28, 4096
    s_add_u32 s35, s28, 8192
    buffer_load_dword v16, v3, s[8:11], s59 offen offset:0
    buffer_load_dword v17, v3, s[8:11], s59 offen offset:256
    buffer_load_dword v18, v3, s[8:11], s59 offen offset:512
    buffer_load_dword v19, v3, s[8:11], s59 offen offset:768
    buffer_load_dword v20, v3, s[8:11], s59 offen offset:1024
    buffer_load_ushort v21, v4, s[12:15], s28 offen offset:0
    buffer_load_ushort v22, v4, s[12:15], s28 offen offset:16
    buffer_load_ushort v23, v4, s[12:15], s28 offen offset:2048
    buffer_load_ushort v24, v4, s[12:15], s28 offen offset:2064
    buffer_load_ushort v25, v4, s[12:15], s29 offen offset:0
    buffer_load_ushort v26, v4, s[12:15], s29 offen offset:16
    buffer_load_ushort v27, v4, s[12:15], s29 offen offset:2048
    buffer_load_ushort v28, v4, s[12:15], s29 offen offset:2064
    buffer_load_ushort v29, v4, s[12:15], s35 offen offset:0
    buffer_load_ushort v30, v4, s[12:15], s35 offen offset:16
    s_cmp_eq_u64 s[30:31], 0
    s_cbranch_scc0 L_t_poll
L_t_have:
    v_mov_b32 v121, 16
    v_mov_b32 v122, s20
    ds_write_b32 v121, v122
    v_lshlrev_b32 v120, 3, v2
    s_waitcnt vmcnt(0)
    v_lshlrev_b32 v124, 16, v16
    v_and_b32 v125, 0xffff0000, v16
    v_lshlrev_b32 v21, 16, v21
    v_lshlrev_b32 v22, 16, v22
    v_add_f32 v124, v124, v21
    v_add_f32 v125, v125, v22
    v_cvt_pk_bf16_f32 v121, v124, v125
    v_lshlrev_b32 v124, 16, v121
    v_and_b32 v125, 0xffff0000, v121
    ds_write_b64 v120, v[124:125] offset:2816
    v_lshlrev_b32 v126, 16, v17
    v_and_b32 v127, 0xffff0000, v17
    v_lshlrev_b32 v23, 16, v23
    v_lshlrev_b32 v24, 16, v24
    v_add_f32 v126, v126, v23
    v_add_f32 v127, v127, v24
    v_cvt_pk_bf16_f32 v121, v126, v127
    v_lshlrev_b32 v126, 16, v121
    v_and_b32 v127, 0xffff0000, v121
    ds_write_b64 v120, v[126:127] offset:3328
    v_lshlrev_b32 v128, 16, v18
    v_and_b32 v129, 0xffff0000, v18
    v_lshlrev_b32 v25, 16, v25
    v_lshlrev_b32 v26, 16, v26
    v_add_f32 v128, v128, v25
    v_add_f32 v129, v129, v26
    v_cvt_pk_bf16_f32 v121, v128, v129
    v_lshlrev_b32 v128, 16, v121
    v_and_b32 v129, 0xffff0000, v121
    ds_write_b64 v120, v[128:129] offset:3840
    v_lshlrev_b32 v130, 16, v19
    v_and_b32 v131, 0xffff0000, v19
    v_lshlrev_b32 v27, 16, v27
    v_lshlrev_b32 v28, 16, v28
    v_add_f32 v130, v130, v27
    v_add_f32 v131, v131, v28
    v_cvt_pk_bf16_f32 v121, v130, v131
    v_lshlrev_b32 v130, 16, v121
    v_and_b32 v131, 0xffff0000, v121
    ds_write_b64 v120, v[130:131] offset:4352
    v_lshlrev_b32 v132, 16, v20
    v_and_b32 v133, 0xffff0000, v20
    v_lshlrev_b32 v29, 16, v29
    v_lshlrev_b32 v30, 16, v30
    v_add_f32 v132, v132, v29
    v_add_f32 v133, v133, v30
    v_cvt_pk_bf16_f32 v121, v132, v133
    v_lshlrev_b32 v132, 16, v121
    v_and_b32 v133, 0xffff0000, v121
    ds_write_b64 v120, v[132:133] offset:4864
    v_add_f32 v134, v124, v125
    v_add_f32 v134, v134, v126
    v_add_f32 v134, v134, v127
    v_add_f32 v134, v134, v128
    v_add_f32 v134, v134, v129
    v_add_f32 v134, v134, v130
    v_add_f32 v134, v134, v131
    v_add_f32 v134, v134, v132
    v_add_f32 v134, v134, v133
    s_nop 1
    v_add_f32_dpp v134, v134, v134 row_shr:1 row_mask:0xf bank_mask:0xf
    s_nop 1
    v_add_f32_dpp v134, v134, v134 row_shr:2 row_mask:0xf bank_mask:0xf
    s_nop 1
    v_add_f32_dpp v134, v134, v134 row_shr:4 row_mask:0xf bank_mask:0xf
    s_nop 1
    v_add_f32_dpp v134, v134, v134 row_shr:8 row_mask:0xf bank_mask:0xf
    s_nop 1
    v_add_f32_dpp v134, v134, v134 row_bcast:15 row_mask:0xa bank_mask:0xf
    s_nop 1
    v_add_f32_dpp v134, v134, v134 row_bcast:31 row_mask:0xc bank_mask:0xf
    s_nop 1
    s_nop 0
    v_mul_f32 v134, 0x3acccccd, v134
    s_nop 0
    v_readlane_b32 s72, v134, 63
    v_cvt_pk_bf16_f32 v134, v134, v134
    v_lshlrev_b32 v134, 16, v134
    s_nop 0
    v_readlane_b32 s73, v134, 63
    v_subrev_f32 v135, s72, v124
    v_mul_f32 v134, v135, v135
    v_subrev_f32 v135, s72, v125
    v_fmac_f32 v134, v135, v135
    v_subrev_f32 v135, s72, v126
    v_fmac_f32 v134, v135, v135
    v_subrev_f32 v135, s72, v127
    v_fmac_f32 v134, v135, v135
    v_subrev_f32 v135, s72, v128
    v_fmac_f32 v134, v135, v135
    v_subrev_f32 v135, s72, v129
    v_fmac_f32 v134, v135, v135
    v_subrev_f32 v135, s72, v130
    v_fmac_f32 v134, v135, v135
    v_subrev_f32 v135, s72, v131
    v_fmac_f32 v134, v135, v135
    v_subrev_f32 v135, s72, v132
    v_fmac_f32 v134, v135, v135
    v_subrev_f32 v135, s72, v133
    v_fmac_f32 v134, v135, v135
    s_nop 1
    v_add_f32_dpp v134, v134, v134 row_shr:1 row_mask:0xf bank_mask:0xf
    s_nop 1
    v_add_f32_dpp v134, v134, v134 row_shr:2 row_mask:0xf bank_mask:0xf
    s_nop 1
    v_add_f32_dpp v134, v134, v134 row_shr:4 row_mask:0xf bank_mask:0xf
    s_nop 1
    v_add_f32_dpp v134, v134, v134 row_shr:8 row_mask:0xf bank_mask:0xf
    s_nop 1
    v_add_f32_dpp v134, v134, v134 row_bcast:15 row_mask:0xa bank_mask:0xf
    s_nop 1
    v_add_f32_dpp v134, v134, v134 row_bcast:31 row_mask:0xc bank_mask:0xf
    s_nop 1
    s_nop 0
    v_mul_f32 v134, 0x3acccccd, v134
    v_cvt_pk_bf16_f32 v134, v134, v134
    v_lshlrev_b32 v134, 16, v134
    v_add_f32 v134, 0x3727c5ac, v134
    v_cvt_pk_bf16_f32 v134, v134, v134
    v_lshlrev_b32 v134, 16, v134
    v_sqrt_f32 v134, v134
    s_nop 0
    v_cvt_pk_bf16_f32 v134, v134, v134
    v_lshlrev_b32 v134, 16, v134
    v_rcp_f32 v134, v134
    s_nop 0
    v_readlane_b32 s74, v134, 63
    s_nop 1
    v_subrev_f32 v124, s73, v124
    v_subrev_f32 v125, s73, v125
    v_cvt_pk_bf16_f32 v121, v124, v125
    v_lshlrev_b32 v124, 16, v121
    v_and_b32 v125, 0xffff0000, v121
    v_mul_f32 v124, s74, v124
    v_mul_f32 v125, s74, v125
    v_cvt_pk_bf16_f32 v121, v124, v125
    v_lshlrev_b32 v124, 16, v121
    v_and_b32 v125, 0xffff0000, v121
    ds_write_b64 v120, v[124:125] offset:256
    v_subrev_f32 v126, s73, v126
    v_subrev_f32 v127, s73, v127
    v_cvt_pk_bf16_f32 v121, v126, v127
    v_lshlrev_b32 v126, 16, v121
    v_and_b32 v127, 0xffff0000, v121
    v_mul_f32 v126, s74, v126
    v_mul_f32 v127, s74, v127
    v_cvt_pk_bf16_f32 v121, v126, v127
    v_lshlrev_b32 v126, 16, v121
    v_and_b32 v127, 0xffff0000, v121
    ds_write_b64 v120, v[126:127] offset:768
    v_subrev_f32 v128, s73, v128
    v_subrev_f32 v129, s73, v129
    v_cvt_pk_bf16_f32 v121, v128, v129
    v_lshlrev_b32 v128, 16, v121
    v_and_b32 v129, 0xffff0000, v121
    v_mul_f32 v128, s74, v128
    v_mul_f32 v129, s74, v129
    v_cvt_pk_bf16_f32 v121, v128, v129
    v_lshlrev_b32 v128, 16, v121
    v_and_b32 v129, 0xffff0000, v121
    ds_write_b64 v120, v[128:129] offset:1280
    v_subrev_f32 v130, s73, v130
    v_subrev_f32 v131, s73, v131
    v_cvt_pk_bf16_f32 v121, v130, v131
    v_lshlrev_b32 v130, 16, v121
    v_and_b32 v131, 0xffff0000, v121
    v_mul_f32 v130, s74, v130
    v_mul_f32 v131, s74, v131
    v_cvt_pk_bf16_f32 v121, v130, v131
    v_lshlrev_b32 v130, 16, v121
    v_and_b32 v131, 0xffff0000, v121
    ds_write_b64 v120, v[130:131] offset:1792
    v_subrev_f32 v132, s73, v132
    v_subrev_f32 v133, s73, v133
    v_cvt_pk_bf16_f32 v121, v132, v133
    v_lshlrev_b32 v132, 16, v121
    v_and_b32 v133, 0xffff0000, v121
    v_mul_f32 v132, s74, v132
    v_mul_f32 v133, s74, v133
    v_cvt_pk_bf16_f32 v121, v132, v133
    v_lshlrev_b32 v132, 16, v121
    v_and_b32 v133, 0xffff0000, v121
    ds_write_b64 v120, v[132:133] offset:2304
    s_cmp_lt_u32 s2, 192
    s_cbranch_scc1 L_t_w3done
    buffer_load_dwordx4 v[80:83], v117, s[64:67], s22 offen
    buffer_load_dword v84, v117, s[64:67], s22 offen offset:16
    s_add_u32 s22, s22, 327680
    buffer_load_dwordx4 v[86:89], v117, s[64:67], s22 offen
    buffer_load_dword v90, v117, s[64:67], s22 offen offset:16
    s_add_u32 s22, s22, 327680
    buffer_load_dwordx4 v[92:95], v117, s[64:67], s22 offen
    buffer_load_dword v96, v117, s[64:67], s22 offen offset:16
    s_add_u32 s22, s22, 327680
    buffer_load_dwordx4 v[98:101], v117, s[64:67], s22 offen
    buffer_load_dword v102, v117, s[64:67], s22 offen offset:16
    s_add_u32 s22, s22, 327680
    buffer_load_dwordx4 v[104:107], v117, s[64:67], s22 offen
    buffer_load_dword v108, v117, s[64:67], s22 offen offset:16
    s_add_u32 s22, s22, 327680
    buffer_load_dwordx4 v[110:113], v117, s[64:67], s22 offen
    buffer_load_dword v114, v117, s[64:67], s22 offen offset:16
L_t_w3done:
    s_waitcnt lgkmcnt(0)
L_t_wait:
    s_barrier
    v_mov_b32 v121, 16
    ds_read_b32 v76, v121
    v_lshlrev_b32 v5, 2, v116
    ds_read_b32 v28, v5 offset:256
    ds_read_b32 v29, v5 offset:768
    ds_read_b32 v30, v5 offset:1280
    ds_read_b32 v31, v5 offset:1792
    ds_read_b32 v32, v5 offset:2304
    s_waitcnt lgkmcnt(5)
    v_readfirstlane_b32 s20, v76
    s_nop 3
    s_and_b32 s21, s20, 0xffff
    s_sub_u32 s21, 0xffff, s21
    s_cmp_ge_u32 s2, 192
    s_cbranch_scc1 L_t_nw
    s_waitcnt vmcnt(0) lgkmcnt(0)
L_t_nw:
    s_cmp_eq_u32 s26, 0
    s_cbranch_scc1 L_t_nodef
    s_cmp_eq_u32 s20, s24
    s_cbranch_scc1 L_t_nodef
    s_cmp_eq_u32 s26, 2
    s_cbranch_scc1 L_t_def1
    buffer_store_dword v6, v3, s[44:47], s17 offen offset:0
    buffer_store_dword v7, v3, s[44:47], s17 offen offset:256
    buffer_store_dword v8, v3, s[44:47], s17 offen offset:512
    buffer_store_dword v9, v3, s[44:47], s17 offen offset:768
    buffer_store_dword v10, v3, s[44:47], s17 offen offset:1024
    s_branch L_t_nodef
L_t_def1:
    buffer_store_dword v11, v3, s[44:47], s17 offen offset:1280
    buffer_store_dword v12, v3, s[44:47], s17 offen offset:1536
    buffer_store_dword v13, v3, s[44:47], s17 offen offset:1792
    buffer_store_dword v14, v3, s[44:47], s17 offen offset:2048
    buffer_store_dword v15, v3, s[44:47], s17 offen offset:2304
L_t_nodef:
    s_cmp_ge_u32 s2, 192
    s_cbranch_scc1 L_t_ffn2
    v_lshlrev_b32 v44, 16, v80
    v_and_b32 v45, 0xffff0000, v80
    v_mul_f32 v36, v28, v44
    v_mul_f32 v37, v28, v45
    v_lshlrev_b32 v44, 16, v81
    v_and_b32 v45, 0xffff0000, v81
    v_mul_f32 v38, v28, v44
    v_mul_f32 v39, v28, v45
    v_lshlrev_b32 v44, 16, v82
    v_and_b32 v45, 0xffff0000, v82
    v_mul_f32 v40, v28, v44
    v_mul_f32 v41, v28, v45
    v_lshlrev_b32 v44, 16, v83
    v_and_b32 v45, 0xffff0000, v83
    v_mul_f32 v42, v28, v44
    v_mul_f32 v43, v28, v45
    v_lshlrev_b32 v44, 16, v84
    v_and_b32 v45, 0xffff0000, v84
    v_fmac_f32 v36, v29, v44
    v_fmac_f32 v37, v29, v45
    v_lshlrev_b32 v44, 16, v85
    v_and_b32 v45, 0xffff0000, v85
    v_fmac_f32 v38, v29, v44
    v_fmac_f32 v39, v29, v45
    v_lshlrev_b32 v44, 16, v86
    v_and_b32 v45, 0xffff0000, v86
    v_fmac_f32 v40, v29, v44
    v_fmac_f32 v41, v29, v45
    v_lshlrev_b32 v44, 16, v87
    v_and_b32 v45, 0xffff0000, v87
    v_fmac_f32 v42, v29, v44
    v_fmac_f32 v43, v29, v45
    v_lshlrev_b32 v44, 16, v88
    v_and_b32 v45, 0xffff0000, v88
    v_fmac_f32 v36, v30, v44
    v_fmac_f32 v37, v30, v45
    v_lshlrev_b32 v44, 16, v89
    v_and_b32 v45, 0xffff0000, v89
    v_fmac_f32 v38, v30, v44
    v_fmac_f32 v39, v30, v45
    v_lshlrev_b32 v44, 16, v90
    v_and_b32 v45, 0xffff0000, v90
    v_fmac_f32 v40, v30, v44
    v_fmac_f32 v41, v30, v45
    v_lshlrev_b32 v44, 16, v91
    v_and_b32 v45, 0xffff0000, v91
    v_fmac_f32 v42, v30, v44
    v_fmac_f32 v43, v30, v45
    v_lshlrev_b32 v44, 16, v92
    v_and_b32 v45, 0xffff0000, v92
    v_fmac_f32 v36, v31, v44
    v_fmac_f32 v37, v31, v45
    v_lshlrev_b32 v44, 16, v93
    v_and_b32 v45, 0xffff0000, v93
    v_fmac_f32 v38, v31, v44
    v_fmac_f32 v39, v31, v45
    v_lshlrev_b32 v44, 16, v94
    v_and_b32 v45, 0xffff0000, v94
    v_fmac_f32 v40, v31, v44
    v_fmac_f32 v41, v31, v45
    v_lshlrev_b32 v44, 16, v95
    v_and_b32 v45, 0xffff0000, v95
    v_fmac_f32 v42, v31, v44
    v_fmac_f32 v43, v31, v45
    v_lshlrev_b32 v44, 16, v96
    v_and_b32 v45, 0xffff0000, v96
    v_fmac_f32 v36, v32, v44
    v_fmac_f32 v37, v32, v45
    v_lshlrev_b32 v44, 16, v97
    v_and_b32 v45, 0xffff0000, v97
    v_fmac_f32 v38, v32, v44
    v_fmac_f32 v39, v32, v45
    v_lshlrev_b32 v44, 16, v98
    v_and_b32 v45, 0xffff0000, v98
    v_fmac_f32 v40, v32, v44
    v_fmac_f32 v41, v32, v45
    v_lshlrev_b32 v44, 16, v99
    v_and_b32 v45, 0xffff0000, v99
    v_fmac_f32 v42, v32, v44
    v_fmac_f32 v43, v32, v45
    s_nop 1
    v_add_f32_dpp v36, v36, v36 row_shr:1 row_mask:0xf bank_mask:0xf
    v_add_f32_dpp v37, v37, v37 row_shr:1 row_mask:0xf bank_mask:0xf
    v_add_f32_dpp v38, v38, v38 row_shr:1 row_mask:0xf bank_mask:0xf
    v_add_f32_dpp v39, v39, v39 row_shr:1 row_mask:0xf bank_mask:0xf
    v_add_f32_dpp v40, v40, v40 row_shr:1 row_mask:0xf bank_mask:0xf
    v_add_f32_dpp v41, v41, v41 row_shr:1 row_mask:0xf bank_mask:0xf
    v_add_f32_dpp v42, v42, v42 row_shr:1 row_mask:0xf bank_mask:0xf
    v_add_f32_dpp v43, v43, v43 row_shr:1 row_mask:0xf bank_mask:0xf
    v_add_f32_dpp v36, v36, v36 row_shr:2 row_mask:0xf bank_mask:0xf
    v_add_f32_dpp v37, v37, v37 row_shr:2 row_mask:0xf bank_mask:0xf
    v_add_f32_dpp v38, v38, v38 row_shr:2 row_mask:0xf bank_mask:0xf
    v_add_f32_dpp v39, v39, v39 row_shr:2 row_mask:0xf bank_mask:0xf
    v_add_f32_dpp v40, v40, v40 row_shr:2 row_mask:0xf bank_mask:0xf
    v_add_f32_dpp v41, v41, v41 row_shr:2 row_mask:0xf bank_mask:0xf
    v_add_f32_dpp v42, v42, v42 row_shr:2 row_mask:0xf bank_mask:0xf
    v_add_f32_dpp v43, v43, v43 row_shr:2 row_mask:0xf bank_mask:0xf
    v_add_f32_dpp v36, v36, v36 row_shr:4 row_mask:0xf bank_mask:0xf
    v_add_f32_dpp v37, v37, v37 row_shr:4 row_mask:0xf bank_mask:0xf
    v_add_f32_dpp v38, v38, v38 row_shr:4 row_mask:0xf bank_mask:0xf
    v_add_f32_dpp v39, v39, v39 row_shr:4 row_mask:0xf bank_mask:0xf
    v_add_f32_dpp v40, v40, v40 row_shr:4 row_mask:0xf bank_mask:0xf
    v_add_f32_dpp v41, v41, v41 row_shr:4 row_mask:0xf bank_mask:0xf
    v_add_f32_dpp v42, v42, v42 row_shr:4 row_mask:0xf bank_mask:0xf
    v_add_f32_dpp v43, v43, v43 row_shr:4 row_mask:0xf bank_mask:0xf
    v_add_f32_dpp v36, v36, v36 row_shr:8 row_mask:0xf bank_mask:0xf
    v_add_f32_dpp v37, v37, v37 row_shr:8 row_mask:0xf bank_mask:0xf
    v_add_f32_dpp v38, v38, v38 row_shr:8 row_mask:0xf bank_mask:0xf
    v_add_f32_dpp v39, v39, v39 row_shr:8 row_mask:0xf bank_mask:0xf
    v_add_f32_dpp v40, v40, v40 row_shr:8 row_mask:0xf bank_mask:0xf
    v_add_f32_dpp v41, v41, v41 row_shr:8 row_mask:0xf bank_mask:0xf
    v_add_f32_dpp v42, v42, v42 row_shr:8 row_mask:0xf bank_mask:0xf
    v_add_f32_dpp v43, v43, v43 row_shr:8 row_mask:0xf bank_mask:0xf
    v_add_f32_dpp v36, v36, v36 row_bcast:15 row_mask:0xa bank_mask:0xf
    v_add_f32_dpp v37, v37, v37 row_bcast:15 row_mask:0xa bank_mask:0xf
    v_add_f32_dpp v38, v38, v38 row_bcast:15 row_mask:0xa bank_mask:0xf
    v_add_f32_dpp v39, v39, v39 row_bcast:15 row_mask:0xa bank_mask:0xf
    v_add_f32_dpp v40, v40, v40 row_bcast:15 row_mask:0xa bank_mask:0xf
    v_add_f32_dpp v41, v41, v41 row_bcast:15 row_mask:0xa bank_mask:0xf
    v_add_f32_dpp v42, v42, v42 row_bcast:15 row_mask:0xa bank_mask:0xf
    v_add_f32_dpp v43, v43, v43 row_bcast:15 row_mask:0xa bank_mask:0xf
    v_add_f32_dpp v36, v36, v36 row_bcast:31 row_mask:0xc bank_mask:0xf
    v_add_f32_dpp v37, v37, v37 row_bcast:31 row_mask:0xc bank_mask:0xf
    v_add_f32_dpp v38, v38, v38 row_bcast:31 row_mask:0xc bank_mask:0xf
    v_add_f32_dpp v39, v39, v39 row_bcast:31 row_mask:0xc bank_mask:0xf
    v_add_f32_dpp v40, v40, v40 row_bcast:31 row_mask:0xc bank_mask:0xf
    v_add_f32_dpp v41, v41, v41 row_bcast:31 row_mask:0xc bank_mask:0xf
    v_add_f32_dpp v42, v42, v42 row_bcast:31 row_mask:0xc bank_mask:0xf
    v_add_f32_dpp v43, v43, v43 row_bcast:31 row_mask:0xc bank_mask:0xf
    s_lshl_b32 s22, s3, 5
    s_add_u32 s22, s22, 64
    v_mov_b32 v46, s22
    v_cmp_eq_u32 vcc, 63, v2
    s_and_saveexec_b64 s[30:31], vcc
    ds_write_b128 v46, v[36:39]
    ds_write_b128 v46, v[40:43] offset:16
    s_mov_b64 exec, s[30:31]
    s_waitcnt lgkmcnt(0)
    s_barrier
    s_cmp_lg_u32 s3, 0
    s_cbranch_scc1 L_t_end
    v_and_b32 v46, 7, v2
    v_lshlrev_b32 v46, 2, v46
    ds_read_b32 v47, v46 offset:64
    ds_read_b32 v48, v46 offset:96
    ds_read_b32 v49, v46 offset:128
    ds_read_b32 v50, v46 offset:160
    s_waitcnt lgkmcnt(0)
    v_add_f32 v47, v47, v48
    v_add_f32 v49, v49, v50
    v_cvt_pk_bf16_f32 v51, v47, v49
    v_lshlrev_b32 v47, 16, v51
    v_and_b32 v49, 0xffff0000, v51
    v_mul_f32 v52, 0xbfb8aa3b, v47
    v_exp_f32 v52, v52
    s_nop 0
    v_add_f32 v52, 1.0, v52
    v_rcp_f32 v52, v52
    s_nop 0
    v_mul_f32 v47, v47, v52
    v_cvt_pk_bf16_f32 v47, v47, v47
    v_lshlrev_b32 v47, 16, v47
    v_mul_f32 v47, v47, v49
    v_cvt_pk_bf16_f32 v47, v47, v47
    v_and_b32 v47, 0xffff, v47
    s_nop 0
    v_readlane_b32 s72, v47, 0
    v_readlane_b32 s73, v47, 1
    v_readlane_b32 s74, v47, 2
    v_readlane_b32 s75, v47, 3
    v_readlane_b32 s76, v47, 4
    v_readlane_b32 s77, v47, 5
    v_readlane_b32 s78, v47, 6
    v_readlane_b32 s79, v47, 7
    s_nop 3
    s_lshl_b32 s73, s73, 16
    s_or_b32 s72, s72, s73
    s_lshl_b32 s75, s75, 16
    s_or_b32 s74, s74, s75
    s_lshl_b32 s77, s77, 16
    s_or_b32 s76, s76, s77
    s_lshl_b32 s79, s79, 16
    s_or_b32 s78, s78, s79
    v_cmp_eq_u32 vcc, 0, v2
    v_mov_b32 v36, s76
    v_mov_b32 v37, s78
    v_mov_b32 v40, s72
    v_mov_b32 v41, s74
    v_cndmask_b32 v36, v36, v40, vcc
    v_cndmask_b32 v37, v37, v41, vcc
    v_mov_b32 v38, 1
    v_mov_b32 v39, 1
    v_lshlrev_b32 v46, 4, v2
    s_lshl_b32 s22, s56, 5
    s_add_u32 s22, s22, 13697024
    v_cmp_gt_u32 vcc, 2, v2
    s_and_saveexec_b64 s[30:31], vcc
    buffer_store_dwordx4 v[36:39], v46, s[12:15], s22 offen sc1
    s_mov_b64 exec, s[30:31]
    s_branch L_t_end
L_t_ffn2:
    v_lshrrev_b32 v118, 2, v0
    v_lshlrev_b32 v118, 4, v118
    s_mov_b32 s27, 13697024
    s_add_u32 s28, s27, 4096
    v_and_b32 v119, 2, v0
    v_cmp_ne_u32 s[32:33], 0, v119
    v_and_b32 v119, 1, v0
    v_cmp_ne_u32 s[34:35], 0, v119
    s_lshr_b32 s26, s20, 16
    s_xor_b32 s23, s26, 0xffff
    s_and_b32 s29, s26, 0x7fff
    s_bitcmp1_b32 s26, 15
    s_cselect_b32 s26, s29, s23
    s_lshl_b32 s26, s26, 16
    v_mov_b32 v70, s26
    v_mul_f32 v70, 0xbfb8aa3b, v70
    v_exp_f32 v70, v70
    s_nop 0
    v_add_f32 v70, 1.0, v70
    v_rcp_f32 v70, v70
    s_nop 0
    v_cvt_pk_bf16_f32 v70, v70, v70
    v_lshlrev_b32 v70, 16, v70
    s_mul_i32 s23, s56, 10
    v_min_u32 v71, 9, v0
    v_add_u32 v71, s23, v71
    v_lshlrev_b32 v72, 2, v71
    ds_read_b32 v73, v72 offset:256
    ds_read_b32 v74, v72 offset:2816
    v_lshlrev_b32 v71, 1, v71
    s_mul_i32 s21, s21, 1280
L_t_poll2:
    buffer_load_dwordx4 v[32:35], v118, s[12:15], s27 offen offset:0 sc1
    buffer_load_dwordx4 v[36:39], v118, s[12:15], s27 offen offset:1024 sc1
    buffer_load_dwordx4 v[40:43], v118, s[12:15], s27 offen offset:2048 sc1
    buffer_load_dwordx4 v[44:47], v118, s[12:15], s27 offen offset:3072 sc1
    buffer_load_dwordx4 v[48:51], v118, s[12:15], s28 offen offset:0 sc1
    buffer_load_dwordx4 v[52:55], v118, s[12:15], s28 offen offset:1024 sc1
    s_waitcnt vmcnt(0)
    v_min3_u32 v56, v34, v38, v42
    v_min3_u32 v57, v46, v50, v54
    v_min_u32 v56, v56, v57
    v_cmp_eq_u32 vcc, 0, v56
    s_nop 1
    s_cmp_eq_u64 vcc, 0
    s_cbranch_scc1 L_t_ready2
    s_sleep 1
    s_branch L_t_poll2
L_t_ready2:
    v_cndmask_b32 v32, v32, v33, s[32:33]
    v_lshlrev_b32 v33, 16, v32
    v_and_b32 v32, 0xffff0000, v32
    v_cndmask_b32 v32, v33, v32, s[34:35]
    v_cndmask_b32 v36, v36, v37, s[32:33]
    v_lshlrev_b32 v37, 16, v36
    v_and_b32 v36, 0xffff0000, v36
    v_cndmask_b32 v36, v37, v36, s[34:35]
    v_cndmask_b32 v40, v40, v41, s[32:33]
    v_lshlrev_b32 v41, 16, v40
    v_and_b32 v40, 0xffff0000, v40
    v_cndmask_b32 v40, v41, v40, s[34:35]
    v_cndmask_b32 v44, v44, v45, s[32:33]
    v_lshlrev_b32 v45, 16, v44
    v_and_b32 v44, 0xffff0000, v44
    v_cndmask_b32 v44, v45, v44, s[34:35]
    v_cndmask_b32 v48, v48, v49, s[32:33]
    v_lshlrev_b32 v49, 16, v48
    v_and_b32 v48, 0xffff0000, v48
    v_cndmask_b32 v48, v49, v48, s[34:35]
    v_cndmask_b32 v52, v52, v53, s[32:33]
    v_lshlrev_b32 v53, 16, v52
    v_and_b32 v52, 0xffff0000, v52
    v_cndmask_b32 v52, v53, v52, s[34:35]
    v_lshlrev_b32 v68, 16, v80
    v_and_b32 v69, 0xffff0000, v80
    v_mul_f32 v56, v32, v68
    v_mul_f32 v57, v32, v69
    v_lshlrev_b32 v68, 16, v81
    v_and_b32 v69, 0xffff0000, v81
    v_mul_f32 v58, v32, v68
    v_mul_f32 v59, v32, v69
    v_lshlrev_b32 v68, 16, v82
    v_and_b32 v69, 0xffff0000, v82
    v_mul_f32 v60, v32, v68
    v_mul_f32 v61, v32, v69
    v_lshlrev_b32 v68, 16, v83
    v_and_b32 v69, 0xffff0000, v83
    v_mul_f32 v62, v32, v68
    v_mul_f32 v63, v32, v69
    v_lshlrev_b32 v68, 16, v84
    v_and_b32 v69, 0xffff0000, v84
    v_mul_f32 v64, v32, v68
    v_mul_f32 v65, v32, v69
    v_lshlrev_b32 v68, 16, v86
    v_and_b32 v69, 0xffff0000, v86
    v_fmac_f32 v56, v36, v68
    v_fmac_f32 v57, v36, v69
    v_lshlrev_b32 v68, 16, v87
    v_and_b32 v69, 0xffff0000, v87
    v_fmac_f32 v58, v36, v68
    v_fmac_f32 v59, v36, v69
    v_lshlrev_b32 v68, 16, v88
    v_and_b32 v69, 0xffff0000, v88
    v_fmac_f32 v60, v36, v68
    v_fmac_f32 v61, v36, v69
    v_lshlrev_b32 v68, 16, v89
    v_and_b32 v69, 0xffff0000, v89
    v_fmac_f32 v62, v36, v68
    v_fmac_f32 v63, v36, v69
    v_lshlrev_b32 v68, 16, v90
    v_and_b32 v69, 0xffff0000, v90
    v_fmac_f32 v64, v36, v68
    v_fmac_f32 v65, v36, v69
    v_lshlrev_b32 v68, 16, v92
    v_and_b32 v69, 0xffff0000, v92
    v_fmac_f32 v56, v40, v68
    v_fmac_f32 v57, v40, v69
    v_lshlrev_b32 v68, 16, v93
    v_and_b32 v69, 0xffff0000, v93
    v_fmac_f32 v58, v40, v68
    v_fmac_f32 v59, v40, v69
    v_lshlrev_b32 v68, 16, v94
    v_and_b32 v69, 0xffff0000, v94
    v_fmac_f32 v60, v40, v68
    v_fmac_f32 v61, v40, v69
    v_lshlrev_b32 v68, 16, v95
    v_and_b32 v69, 0xffff0000, v95
    v_fmac_f32 v62, v40, v68
    v_fmac_f32 v63, v40, v69
    v_lshlrev_b32 v68, 16, v96
    v_and_b32 v69, 0xffff0000, v96
    v_fmac_f32 v64, v40, v68
    v_fmac_f32 v65, v40, v69
    v_lshlrev_b32 v68, 16, v98
    v_and_b32 v69, 0xffff0000, v98
    v_fmac_f32 v56, v44, v68
    v_fmac_f32 v57, v44, v69
    v_lshlrev_b32 v68, 16, v99
    v_and_b32 v69, 0xffff0000, v99
    v_fmac_f32 v58, v44, v68
    v_fmac_f32 v59, v44, v69
    v_lshlrev_b32 v68, 16, v100
    v_and_b32 v69, 0xffff0000, v100
    v_fmac_f32 v60, v44, v68
    v_fmac_f32 v61, v44, v69
    v_lshlrev_b32 v68, 16, v101
    v_and_b32 v69, 0xffff0000, v101
    v_fmac_f32 v62, v44, v68
    v_fmac_f32 v63, v44, v69
    v_lshlrev_b32 v68, 16, v102
    v_and_b32 v69, 0xffff0000, v102
    v_fmac_f32 v64, v44, v68
    v_fmac_f32 v65, v44, v69
    v_lshlrev_b32 v68, 16, v104
    v_and_b32 v69, 0xffff0000, v104
    v_fmac_f32 v56, v48, v68
    v_fmac_f32 v57, v48, v69
    v_lshlrev_b32 v68, 16, v105
    v_and_b32 v69, 0xffff0000, v105
    v_fmac_f32 v58, v48, v68
    v_fmac_f32 v59, v48, v69
    v_lshlrev_b32 v68, 16, v106
    v_and_b32 v69, 0xffff0000, v106
    v_fmac_f32 v60, v48, v68
    v_fmac_f32 v61, v48, v69
    v_lshlrev_b32 v68, 16, v107
    v_and_b32 v69, 0xffff0000, v107
    v_fmac_f32 v62, v48, v68
    v_fmac_f32 v63, v48, v69
    v_lshlrev_b32 v68, 16, v108
    v_and_b32 v69, 0xffff0000, v108
    v_fmac_f32 v64, v48, v68
    v_fmac_f32 v65, v48, v69
    v_lshlrev_b32 v68, 16, v110
    v_and_b32 v69, 0xffff0000, v110
    v_fmac_f32 v56, v52, v68
    v_fmac_f32 v57, v52, v69
    v_lshlrev_b32 v68, 16, v111
    v_and_b32 v69, 0xffff0000, v111
    v_fmac_f32 v58, v52, v68
    v_fmac_f32 v59, v52, v69
    v_lshlrev_b32 v68, 16, v112
    v_and_b32 v69, 0xffff0000, v112
    v_fmac_f32 v60, v52, v68
    v_fmac_f32 v61, v52, v69
    v_lshlrev_b32 v68, 16, v113
    v_and_b32 v69, 0xffff0000, v113
    v_fmac_f32 v62, v52, v68
    v_fmac_f32 v63, v52, v69
    v_lshlrev_b32 v68, 16, v114
    v_and_b32 v69, 0xffff0000, v114
    v_fmac_f32 v64, v52, v68
    v_fmac_f32 v65, v52, v69
    s_nop 1
    v_add_f32_dpp v56, v56, v56 row_shr:1 row_mask:0xf bank_mask:0xf
    v_add_f32_dpp v57, v57, v57 row_shr:1 row_mask:0xf bank_mask:0xf
    v_add_f32_dpp v58, v58, v58 row_shr:1 row_mask:0xf bank_mask:0xf
    v_add_f32_dpp v59, v59, v59 row_shr:1 row_mask:0xf bank_mask:0xf
    v_add_f32_dpp v60, v60, v60 row_shr:1 row_mask:0xf bank_mask:0xf
    v_add_f32_dpp v61, v61, v61 row_shr:1 row_mask:0xf bank_mask:0xf
    v_add_f32_dpp v62, v62, v62 row_shr:1 row_mask:0xf bank_mask:0xf
    v_add_f32_dpp v63, v63, v63 row_shr:1 row_mask:0xf bank_mask:0xf
    v_add_f32_dpp v64, v64, v64 row_shr:1 row_mask:0xf bank_mask:0xf
    v_add_f32_dpp v65, v65, v65 row_shr:1 row_mask:0xf bank_mask:0xf
    v_add_f32_dpp v56, v56, v56 row_shr:2 row_mask:0xf bank_mask:0xf
    v_add_f32_dpp v57, v57, v57 row_shr:2 row_mask:0xf bank_mask:0xf
    v_add_f32_dpp v58, v58, v58 row_shr:2 row_mask:0xf bank_mask:0xf
    v_add_f32_dpp v59, v59, v59 row_shr:2 row_mask:0xf bank_mask:0xf
    v_add_f32_dpp v60, v60, v60 row_shr:2 row_mask:0xf bank_mask:0xf
    v_add_f32_dpp v61, v61, v61 row_shr:2 row_mask:0xf bank_mask:0xf
    v_add_f32_dpp v62, v62, v62 row_shr:2 row_mask:0xf bank_mask:0xf
    v_add_f32_dpp v63, v63, v63 row_shr:2 row_mask:0xf bank_mask:0xf
    v_add_f32_dpp v64, v64, v64 row_shr:2 row_mask:0xf bank_mask:0xf
    v_add_f32_dpp v65, v65, v65 row_shr:2 row_mask:0xf bank_mask:0xf
    v_add_f32_dpp v56, v56, v56 row_shr:4 row_mask:0xf bank_mask:0xf
    v_add_f32_dpp v57, v57, v57 row_shr:4 row_mask:0xf bank_mask:0xf
    v_add_f32_dpp v58, v58, v58 row_shr:4 row_mask:0xf bank_mask:0xf
    v_add_f32_dpp v59, v59, v59 row_shr:4 row_mask:0xf bank_mask:0xf
    v_add_f32_dpp v60, v60, v60 row_shr:4 row_mask:0xf bank_mask:0xf
    v_add_f32_dpp v61, v61, v61 row_shr:4 row_mask:0xf bank_mask:0xf
    v_add_f32_dpp v62, v62, v62 row_shr:4 row_mask:0xf bank_mask:0xf
    v_add_f32_dpp v63, v63, v63 row_shr:4 row_mask:0xf bank_mask:0xf
    v_add_f32_dpp v64, v64, v64 row_shr:4 row_mask:0xf bank_mask:0xf
    v_add_f32_dpp v65, v65, v65 row_shr:4 row_mask:0xf bank_mask:0xf
    v_add_f32_dpp v56, v56, v56 row_shr:8 row_mask:0xf bank_mask:0xf
    v_add_f32_dpp v57, v57, v57 row_shr:8 row_mask:0xf bank_mask:0xf
    v_add_f32_dpp v58, v58, v58 row_shr:8 row_mask:0xf bank_mask:0xf
    v_add_f32_dpp v59, v59, v59 row_shr:8 row_mask:0xf bank_mask:0xf
    v_add_f32_dpp v60, v60, v60 row_shr:8 row_mask:0xf bank_mask:0xf
    v_add_f32_dpp v61, v61, v61 row_shr:8 row_mask:0xf bank_mask:0xf
    v_add_f32_dpp v62, v62, v62 row_shr:8 row_mask:0xf bank_mask:0xf
    v_add_f32_dpp v63, v63, v63 row_shr:8 row_mask:0xf bank_mask:0xf
    v_add_f32_dpp v64, v64, v64 row_shr:8 row_mask:0xf bank_mask:0xf
    v_add_f32_dpp v65, v65, v65 row_shr:8 row_mask:0xf bank_mask:0xf
    v_add_f32_dpp v56, v56, v56 row_bcast:15 row_mask:0xa bank_mask:0xf
    v_add_f32_dpp v57, v57, v57 row_bcast:15 row_mask:0xa bank_mask:0xf
    v_add_f32_dpp v58, v58, v58 row_bcast:15 row_mask:0xa bank_mask:0xf
    v_add_f32_dpp v59, v59, v59 row_bcast:15 row_mask:0xa bank_mask:0xf
    v_add_f32_dpp v60, v60, v60 row_bcast:15 row_mask:0xa bank_mask:0xf
    v_add_f32_dpp v61, v61, v61 row_bcast:15 row_mask:0xa bank_mask:0xf
    v_add_f32_dpp v62, v62, v62 row_bcast:15 row_mask:0xa bank_mask:0xf
    v_add_f32_dpp v63, v63, v63 row_bcast:15 row_mask:0xa bank_mask:0xf
    v_add_f32_dpp v64, v64, v64 row_bcast:15 row_mask:0xa bank_mask:0xf
    v_add_f32_dpp v65, v65, v65 row_bcast:15 row_mask:0xa bank_mask:0xf
    v_add_f32_dpp v56, v56, v56 row_bcast:31 row_mask:0xc bank_mask:0xf
    v_add_f32_dpp v57, v57, v57 row_bcast:31 row_mask:0xc bank_mask:0xf
    v_add_f32_dpp v58, v58, v58 row_bcast:31 row_mask:0xc bank_mask:0xf
    v_add_f32_dpp v59, v59, v59 row_bcast:31 row_mask:0xc bank_mask:0xf
    v_add_f32_dpp v60, v60, v60 row_bcast:31 row_mask:0xc bank_mask:0xf
    v_add_f32_dpp v61, v61, v61 row_bcast:31 row_mask:0xc bank_mask:0xf
    v_add_f32_dpp v62, v62, v62 row_bcast:31 row_mask:0xc bank_mask:0xf
    v_add_f32_dpp v63, v63, v63 row_bcast:31 row_mask:0xc bank_mask:0xf
    v_add_f32_dpp v64, v64, v64 row_bcast:31 row_mask:0xc bank_mask:0xf
    v_add_f32_dpp v65, v65, v65 row_bcast:31 row_mask:0xc bank_mask:0xf
    s_mul_i32 s22, s3, 48
    s_add_u32 s22, s22, 64
    v_mov_b32 v46, s22
    v_cmp_eq_u32 vcc, 63, v2
    s_and_saveexec_b64 s[30:31], vcc
    ds_write_b128 v46, v[56:59]
    ds_write_b128 v46, v[60:63] offset:16
    ds_write_b64 v46, v[64:65] offset:32
    s_mov_b64 exec, s[30:31]
    s_waitcnt lgkmcnt(0)
    s_barrier
    v_cmp_gt_u32 vcc, 10, v0
    s_and_saveexec_b64 s[30:31], vcc
    s_cbranch_execz L_t_end
    v_lshlrev_b32 v46, 2, v0
    ds_read_b32 v47, v46 offset:64
    ds_read_b32 v48, v46 offset:112
    ds_read_b32 v49, v46 offset:160
    ds_read_b32 v50, v46 offset:208
    s_waitcnt lgkmcnt(0)
    v_add_f32 v47, v47, v48
    v_add_f32 v49, v49, v50
    v_add_f32 v47, v47, v49
    v_cvt_pk_bf16_f32 v47, v47, v47
    v_lshlrev_b32 v47, 16, v47
    v_mul_f32 v47, v47, v70
    v_cvt_pk_bf16_f32 v47, v47, v47
    v_lshlrev_b32 v47, 16, v47
    v_add_f32 v47, v47, v73
    v_cvt_pk_bf16_f32 v47, v47, v47
    v_lshlrev_b32 v47, 16, v47
    v_add_f32 v47, v47, v74
    v_cvt_pk_bf16_f32 v47, v47, v47
    buffer_store_short v47, v71, s[44:47], s21 offen
L_t_end:
    s_mov_b64 exec, -1
L_t_done:
    s_endpgm
.section .rodata,"a"
.p2align 6
.amdhsa_kernel ln1_kernel
  .amdhsa_next_free_vgpr 64
  .amdhsa_next_free_sgpr 96
  .amdhsa_accum_offset 64
  .amdhsa_group_segment_fixed_size 0
  .amdhsa_kernarg_size 136
  .amdhsa_user_sgpr_count 2
  .amdhsa_user_sgpr_kernarg_segment_ptr 1
  .amdhsa_system_sgpr_workgroup_id_x 1
.end_amdhsa_kernel
.p2align 6
.amdhsa_kernel main1_kernel
  .amdhsa_next_free_vgpr 161
  .amdhsa_next_free_sgpr 96
  .amdhsa_accum_offset 164
  .amdhsa_group_segment_fixed_size 0
  .amdhsa_kernarg_size 136
  .amdhsa_user_sgpr_count 2
  .amdhsa_user_sgpr_kernarg_segment_ptr 1
  .amdhsa_system_sgpr_workgroup_id_x 1
.end_amdhsa_kernel
.p2align 6
.amdhsa_kernel tail_kernel
  .amdhsa_next_free_vgpr 136
  .amdhsa_next_free_sgpr 96
  .amdhsa_accum_offset 136
  .amdhsa_group_segment_fixed_size 0
  .amdhsa_kernarg_size 136
  .amdhsa_user_sgpr_count 2
  .amdhsa_user_sgpr_kernarg_segment_ptr 1
  .amdhsa_system_sgpr_workgroup_id_x 1
.end_amdhsa_kernel
```
